```python
import torch

def _softmax(x, axis=-1):
    return torch.softmax(x, dim=axis)
def _gelu(x):
    return torch.nn.functional.gelu(x, approximate="tanh")
def _silu(x):
    return torch.nn.functional.silu(x)
def _sigmoid(x):
    return torch.sigmoid(x)
def _layernorm(x, axis=-1, eps=1e-5):
    m = x.mean(dim=axis, keepdim=True)
    v = x.var(dim=axis, keepdim=True, unbiased=False)
    return (x - m) / torch.sqrt(v + eps)
def _scatter_add(tgt, idx, src, axis=0):
    return tgt.clone().index_add_(axis, idx, src)
def _segment_sum(src, seg, n):
    out = torch.zeros((n,) + src.shape[1:], dtype=src.dtype)
    return out.index_add_(0, seg, src)
def _pad(x, pw):
    flat = tuple(v for pair in reversed(pw) for v in pair)
    return torch.nn.functional.pad(x, flat)

kernel_name = 'gather_scatter__edge_featured_mpnn_gatedgcn__graph'

def setup_inputs():

    _w = (lambda a: (lambda t: t.to(torch.bfloat16) if t.is_floating_point() else t)(torch.as_tensor(a)))
    N, deg, D, De = 10000, 64, 64, max(16, 1)
    E = N * deg
    return {
        "x": _w((lambda *s: torch.randn(*s, dtype=torch.bfloat16) * 0.8)(N, D)),
        "e_attr": _w((lambda *s: torch.randn(*s, dtype=torch.bfloat16) * 0.8)(E, De)),
        "src": _w((lambda lo, hi, *s: torch.randint(lo, hi, s))(0, N, E).to(torch.int64)),
        "dst": _w((lambda lo, hi, *s: torch.randint(lo, hi, s))(0, N, E).to(torch.int64)),
        "w_a": _w((lambda *s: torch.randn(*s, dtype=torch.bfloat16) * 0.8)(D, D)),
        "w_b": _w((lambda *s: torch.randn(*s, dtype=torch.bfloat16) * 0.8)(D, D)),
        "w_c": _w((lambda *s: torch.randn(*s, dtype=torch.bfloat16) * 0.8)(De, D)),
        "w_u": _w((lambda *s: torch.randn(*s, dtype=torch.bfloat16) * 0.05)(D, D)),
        "w_v": _w((lambda *s: torch.randn(*s, dtype=torch.bfloat16) * 0.05)(D, D)),
    }

def reference(x, e_attr, src, dst, w_a, w_b, w_c, w_u, w_v):
    N, D = x.shape
    hv = x @ w_v
    g = x[dst] @ w_a + x[src] @ w_b + e_attr @ w_c
    eta = _sigmoid(g)
    denom = _segment_sum(eta, dst, N) + 1e-6
    eta_n = eta / denom[dst]
    agg = _segment_sum(eta_n * hv[src], dst, N)
    z = x @ w_u + agg
    relu_z = torch.where(z > 0, z, 0 * z)
    return x + relu_z
```

```asm
; @launch grid=(256,1,1) block=(512,1,1) lds=123392
.amdgcn_target "amdgcn-amd-amdhsa--gfx950"
.text
.globl gather_scatter__edge_featured_mpnn_gatedgcn__graph_kernel
.p2align 8
.type gather_scatter__edge_featured_mpnn_gatedgcn__graph_kernel,@function
gather_scatter__edge_featured_mpnn_gatedgcn__graph_kernel:
    s_cmp_ge_u32 s2, 256
    s_cbranch_scc1 K_END
    s_load_dwordx4 s[36:39], s[0:1], 16
    v_lshlrev_b32 v14, 4, v0
    s_getpc_b64 s[50:51]
K_PC:
    v_mov_b32 v5, s51
    v_add_co_u32 v4, vcc, s50, v14
    s_nop 1
    v_addc_co_u32 v5, vcc, 0, v5, vcc
    global_load_dwordx4 v[112:115], v[4:5], off
    s_and_b32 s29, s2, 7
    s_lshr_b32 s30, s2, 3
    s_mul_i32 s31, s29, 250
    s_add_u32 s32, s31, 257
    s_add_u32 s31, s31, 7
    s_lshr_b32 s31, s31, 3
    s_lshr_b32 s32, s32, 3
    s_add_u32 s25, s31, s30
    s_cmp_ge_u32 s25, s32
    s_cbranch_scc1 K_END
    s_mul_i32 s33, s25, 10240
    v_lshlrev_b32 v15, 2, v0
    v_add_u32 v15, 8192, v15
    s_mov_b32 s58, 2560000
    s_mov_b32 s59, 0x20000
    s_waitcnt lgkmcnt(0)
    s_mov_b32 s56, s38
    s_mov_b32 s57, s39
    buffer_load_dwordx4 v[16:19], v14, s[56:59], s33 offen
    buffer_load_dword v20, v15, s[56:59], s33 offen
    s_mov_b32 s56, s36
    s_mov_b32 s57, s37
    buffer_load_dwordx4 v[24:27], v14, s[56:59], s33 offen
    buffer_load_dword v28, v15, s[56:59], s33 offen
    s_load_dwordx4 s[4:7], s[0:1], 0
    s_load_dwordx8 s[40:47], s[0:1], 32
    s_load_dwordx2 s[48:49], s[0:1], 64
    s_load_dwordx2 s[20:21], s[0:1], 72
    s_load_dwordx4 s[52:55], s[0:1], 80
    v_mov_b32 v250, v0
    v_readfirstlane_b32 s24, v0
    v_and_b32 v1, 63, v0
    v_lshlrev_b32 v248, 4, v1
    v_mov_b32 v249, 1
    s_mov_b32 s68, 1.0
    s_mov_b32 s69, 1.0
    s_mov_b32 s70, 0xffffff80
    s_lshr_b32 s24, s24, 6
    s_mov_b32 s71, 0xffffffe0
    s_mov_b32 s72, 0x70
    s_mov_b32 s64, 0
    s_mul_i32 s28, s24, 10240
    s_add_u32 s28, s28, 41472
    s_lshr_b32 s98, s24, 2
    v_mov_b32 v4, 0
    v_mov_b32 v5, 0
    v_mov_b32 v6, 0
    v_mov_b32 v7, 0
    v_lshlrev_b32 v12, 4, v250
    v_cmp_gt_u32 vcc, 272, v250
    s_and_saveexec_b64 s[74:75], vcc
    ds_write_b128 v12, v[4:7] offset:4352
    s_mov_b64 exec, s[74:75]
    v_add_u32 v13, 74240, v12
    v_cmp_le_u32 vcc, 448, v250
    s_and_saveexec_b64 s[74:75], vcc
    ds_write_b128 v13, v[4:7]
    s_mov_b64 exec, s[74:75]
    s_waitcnt lgkmcnt(0)
    s_mov_b32 s8, s6
    s_mov_b32 s9, s7
    s_mov_b32 s10, 20480000
    s_mov_b32 s11, 0x20000
    s_mov_b32 s6, 1280000
    s_mov_b32 s7, 0x20000
    s_mov_b32 s12, s54
    s_mov_b32 s13, s55
    s_mov_b32 s14, 2887680
    s_mov_b32 s15, 0x20000
    s_add_u32 s16, s54, 2621440
    s_addc_u32 s17, s55, 0
    s_mov_b32 s18, 256000
    s_mov_b32 s19, 0x20000
    s_mov_b32 s22, 1280000
    s_mov_b32 s23, 0x20000
    s_mov_b32 s60, s52
    s_mov_b32 s61, s53
    s_mov_b32 s62, 256
    s_mov_b32 s63, 0x20000
    s_or_b32 s29, s25, s24
    s_cmp_lg_u32 s29, 0
    s_cbranch_scc1 K_NOTAG
    s_memrealtime s[30:31]
    s_waitcnt lgkmcnt(0)
    s_or_b32 s30, s30, 1
    v_mov_b32 v2, s30
    v_lshlrev_b32 v3, 2, v1
    buffer_store_dword v2, v3, s[60:63], 0 offen sc0 sc1
K_NOTAG:
    v_bfe_u32 v46, v1, 4, 1
    v_lshlrev_b32 v46, 6, v46
    v_xor_b32 v46, v46, v248
    s_lshl_b32 s29, s24, 10
    s_mov_b32 s58, 8192
    s_mov_b32 s59, 0x20000
    s_mov_b32 s56, s42
    s_mov_b32 s57, s43
    s_add_u32 m0, s29, 41472
    s_nop 0
    buffer_load_dwordx4 v46, s[56:59], s29 offen lds
    s_mov_b32 s56, s44
    s_mov_b32 s57, s45
    s_mov_b32 s58, 2048
    s_and_b32 s30, s24, 1
    s_lshl_b32 s30, s30, 10
    s_add_u32 m0, s30, 74240
    s_nop 0
    buffer_load_dwordx4 v46, s[56:59], s30 offen lds
    s_mul_i32 s31, s25, 40
    s_mul_i32 s30, s24, 5
    s_add_u32 s31, s31, s30
    s_lshl_b32 s3, s31, 7
    s_lshl_b32 s34, s24, 11
    s_lshl_b32 s35, s24, 9
    v_and_b32 v2, 31, v1
    v_lshrrev_b32 v3, 5, v1
    v_and_b32 v4, 3, v2
    v_bfe_u32 v5, v2, 4, 1
    v_bfe_u32 v6, v2, 2, 1
    v_bfe_u32 v7, v2, 3, 1
    v_lshlrev_b32 v8, 3, v4
    v_lshl_add_u32 v8, v5, 2, v8
    v_lshl_add_u32 v8, v6, 1, v8
    v_add_u32 v8, v8, v7
    v_lshl_or_b32 v9, v5, 2, v4
    v_xor_b32 v9, v9, v3
    v_lshlrev_b32 v8, 7, v8
    v_add_u32 v8, s28, v8
    v_xor_b32 v10, 0, v9
    v_lshl_add_u32 v224, v10, 4, v8
    v_xor_b32 v10, 2, v9
    v_lshl_add_u32 v225, v10, 4, v8
    v_xor_b32 v10, 4, v9
    v_lshl_add_u32 v226, v10, 4, v8
    v_xor_b32 v10, 6, v9
    v_lshl_add_u32 v227, v10, 4, v8
    v_and_b32 v10, 7, v1
    v_lshlrev_b32 v11, 2, v3
    v_xor_b32 v10, v10, v11
    v_xor_b32 v11, 0, v10
    v_lshlrev_b32 v228, 4, v11
    v_xor_b32 v11, 1, v10
    v_lshlrev_b32 v229, 4, v11
    v_xor_b32 v11, 2, v10
    v_lshlrev_b32 v230, 4, v11
    v_xor_b32 v11, 3, v10
    v_lshlrev_b32 v231, 4, v11
    v_xor_b32 v10, v3, v7
    v_lshl_add_u32 v10, v2, 1, v10
    v_lshlrev_b32 v10, 4, v10
    v_add_u32 v10, s28, v10
    v_add_u32 v232, 4096, v10
    v_bfe_u32 v10, v1, 4, 1
    v_xor_b32 v10, v10, v1
    v_and_b32 v10, 1, v10
    v_lshlrev_b32 v233, 4, v10
    s_add_u32 s36, s34, 8704
    s_add_u32 s37, s34, 25088
    s_add_u32 s38, s35, 4608
    v_lshrrev_b32 v10, 3, v1
    v_lshl_add_u32 v244, v10, 4, s36
    v_and_b32 v10, 0x13, v2
    v_lshl_or_b32 v10, v6, 3, v10
    v_lshl_or_b32 v10, v7, 2, v10
    v_lshl_add_u32 v245, v10, 2, s36
    v_lshrrev_b32 v11, 1, v1
    v_and_b32 v10, 0x13, v11
    v_bfe_u32 v12, v11, 2, 1
    v_bfe_u32 v13, v11, 3, 1
    v_lshl_or_b32 v10, v12, 3, v10
    v_lshl_or_b32 v10, v13, 2, v10
    v_lshl_add_u32 v246, v10, 2, s37
    v_and_b32 v10, 7, v1
    v_lshl_add_u32 v247, v10, 2, s38
    v_and_b32 v2, 31, v1
    v_lshrrev_b32 v3, 5, v1
    v_and_b32 v4, 3, v2
    v_bfe_u32 v7, v2, 3, 1
    v_cmp_gt_u32 vcc, 32, v1
    v_mov_b32 v10, 4
    v_mov_b32 v11, 20
    v_mov_b32 v12, 28
    v_mov_b32 v13, 12
    v_cndmask_b32 v238, v10, v12, vcc
    v_cndmask_b32 v239, v11, v13, vcc
    v_lshrrev_b32 v10, 1, v1
    v_xor_b32 v10, v10, v1
    v_and_b32 v10, 8, v10
    v_cmp_eq_u32 vcc, 0, v10
    v_mov_b32 v11, 0xff0
    v_lshlrev_b32 v241, 7, v3
    v_cndmask_b32 v240, 0, v11, vcc
    v_bfe_u32 v10, v1, 4, 1
    v_lshlrev_b32 v11, 9, v10
    v_and_b32 v12, 15, v1
    v_lshl_add_u32 v12, v3, 4, v12
    v_lshl_add_u32 v12, v12, 1, v11
    s_mul_i32 s39, s24, 640
    s_add_u32 s39, s39, 76288
    v_add_u32 v62, s39, v12
    v_add_u32 v242, s3, v12
    v_mul_u32_u24 v13, 0x7ff000, v10
    v_lshlrev_b32 v13, 8, v13
    v_add_u32 v243, v242, v13
    v_lshl_add_u32 v10, v7, 2, v4
    v_lshlrev_b32 v11, 7, v10
    v_lshl_add_u32 v11, v3, 4, v11
    v_add_u32 v11, s39, v11
    v_cmp_gt_u32 vcc, 5, v10
    v_cmp_gt_u32 s[30:31], 16, v2
    v_mov_b32 v12, 4416
    s_and_b64 vcc, vcc, s[30:31]
    v_and_b32 v10, 7, v1
    v_mov_b32 v13, 16
    v_cndmask_b32 v61, v12, v11, vcc
    v_lshlrev_b32 v10, v10, v13
    v_and_b32 v10, v10, v240
    v_cmp_gt_u32 vcc, 32, v1
    v_bfe_u32 v11, v1, 2, 2
    v_lshl_add_u32 v11, v3, 3, v11
    v_cndmask_b32 v60, 0, v10, vcc
    v_lshlrev_b32 v11, 7, v11
    v_bfe_u32 v12, v1, 4, 1
    v_and_b32 v13, 3, v1
    v_lshl_add_u32 v12, v12, 2, v13
    v_lshl_add_u32 v11, v12, 3, v11
    v_add_u32 v63, 41472, v11
    v_bfe_u32 v12, v1, 3, 1
    v_lshlrev_b32 v12, 6, v12
    v_add_u32 v59, v63, v12
    v_xor_b32 v12, 64, v12
    v_add_u32 v63, v63, v12
    s_lshl_b32 s29, s24, 2
    s_xor_b32 s30, s29, 16
    s_add_u32 s29, s29, 4384
    s_add_u32 s30, s30, 4384
    v_mov_b32 v251, s29
    v_mov_b32 v252, s30
    v_mov_b32 v234, v244
    v_mov_b32 v235, v245
    v_mov_b32 v236, v246
    v_mov_b32 v237, v247
    v_mov_b32 v8, 0x3f80
    v_mov_b32 v9, 0x3f800000
    v_subrev_u32 v3, 256, v250
    v_lshlrev_b32 v12, v3, v249
    v_cmp_gt_u32 vcc, 8, v3
    s_nop 1
    v_cndmask_b32 v12, 0, v12, vcc
    v_cmp_gt_u32 vcc, 256, v250
    s_nop 1
    v_cndmask_b32 v12, v12, v250, vcc
    v_bfe_u32 v10, v12, 0, 1
    v_bfe_u32 v11, v12, 1, 1
    v_mul_lo_u32 v10, v10, v8
    v_mul_lo_u32 v11, v11, v9
    v_or_b32 v4, v10, v11
    v_bfe_u32 v10, v12, 2, 1
    v_bfe_u32 v11, v12, 3, 1
    v_mul_lo_u32 v10, v10, v8
    v_mul_lo_u32 v11, v11, v9
    v_or_b32 v5, v10, v11
    v_bfe_u32 v10, v12, 4, 1
    v_bfe_u32 v11, v12, 5, 1
    v_mul_lo_u32 v10, v10, v8
    v_mul_lo_u32 v11, v11, v9
    v_or_b32 v6, v10, v11
    v_bfe_u32 v10, v12, 6, 1
    v_bfe_u32 v11, v12, 7, 1
    v_mul_lo_u32 v10, v10, v8
    v_mul_lo_u32 v11, v11, v9
    v_or_b32 v7, v10, v11
    v_cmp_gt_u32 vcc, 272, v250
    s_and_saveexec_b64 s[74:75], vcc
    ds_write_b128 v14, v[4:7] offset:0
    s_mov_b64 exec, s[74:75]
    s_mov_b32 s29, 0xffffffd8
    s_mov_b32 s30, -5
    v_lshlrev_b32 v2, 22, v250
    v_lshlrev_b32 v3, 20, v250
    v_add_u32 v3, 0x80000000, v3
    s_waitcnt vmcnt(4) lgkmcnt(0)
    s_barrier
    v_mul_u32_u24 v32, 0xcccd, v16
    v_mul_u32_u24 v33, 0xcccd, v17
    v_mul_u32_u24 v34, 0xcccd, v18
    v_mul_u32_u24 v35, 0xcccd, v19
    v_mul_u32_u24 v36, 0xcccd, v20
    v_lshrrev_b32 v32, 21, v32
    v_lshrrev_b32 v33, 21, v33
    v_lshrrev_b32 v34, 21, v34
    v_lshrrev_b32 v35, 21, v35
    v_lshrrev_b32 v36, 21, v36
    s_mov_b32 s31, 81408
    v_lshl_add_u32 v54, v32, 2, s31
    v_lshl_add_u32 v55, v33, 2, s31
    v_lshl_add_u32 v56, v34, 2, s31
    v_lshl_add_u32 v57, v35, 2, s31
    v_lshl_add_u32 v58, v36, 2, s31
    ds_add_rtn_u32 v40, v54, v249
    ds_add_rtn_u32 v41, v55, v249
    ds_add_rtn_u32 v42, v56, v249
    ds_add_rtn_u32 v43, v57, v249
    ds_add_rtn_u32 v44, v58, v249
    v_mad_i32_i24 v16, v32, s29, v16
    v_mad_i32_i24 v17, v33, s29, v17
    v_mad_i32_i24 v18, v34, s29, v18
    v_mad_i32_i24 v19, v35, s29, v19
    v_mad_i32_i24 v20, v36, s29, v20
    v_mul_u32_u24 v32, 52, v16
    v_mul_u32_u24 v33, 52, v17
    v_mul_u32_u24 v34, 52, v18
    v_mul_u32_u24 v35, 52, v19
    v_mul_u32_u24 v36, 52, v20
    v_lshrrev_b32 v32, 8, v32
    v_lshrrev_b32 v33, 8, v33
    v_lshrrev_b32 v34, 8, v34
    v_lshrrev_b32 v35, 8, v35
    v_lshrrev_b32 v36, 8, v36
    v_mad_i32_i24 v16, v32, s30, v16
    v_mad_i32_i24 v17, v33, s30, v17
    v_mad_i32_i24 v18, v34, s30, v18
    v_mad_i32_i24 v19, v35, s30, v19
    v_mad_i32_i24 v20, v36, s30, v20
    v_lshl_or_b32 v16, v32, 17, v16
    v_lshl_or_b32 v17, v33, 17, v17
    v_lshl_or_b32 v18, v34, 17, v18
    v_lshl_or_b32 v19, v35, 17, v19
    v_lshl_or_b32 v20, v36, 17, v20
    v_mov_b32 v48, v2
    v_add_u32 v49, 1048576, v2
    v_add_u32 v50, 2097152, v2
    v_add_u32 v51, 3145728, v2
    v_mov_b32 v52, v3
    v_or_b32 v16, v16, v48
    v_or_b32 v17, v17, v49
    v_or_b32 v18, v18, v50
    v_or_b32 v19, v19, v51
    v_or_b32 v20, v20, v52
    s_waitcnt vmcnt(2)
    v_lshl_or_b32 v48, v24, 3, v16
    v_lshl_or_b32 v49, v25, 3, v17
    v_lshl_or_b32 v50, v26, 3, v18
    v_lshl_or_b32 v51, v27, 3, v19
    v_lshl_or_b32 v52, v28, 3, v20
    s_waitcnt vmcnt(0) lgkmcnt(0)
    s_barrier
    s_cmp_lg_u32 s24, 0
    s_cbranch_scc1 K_NOSCAN
    v_add_u32 v9, 81408, v248
    ds_read_b128 v[4:7], v9
    s_and_b32 s29, s2, 63
    s_lshl_b32 s29, s29, 2
    v_mov_b32 v10, s29
    buffer_load_dword v29, v10, s[60:63], 0 offen sc0 sc1
    s_waitcnt lgkmcnt(0)
    v_add_u32 v5, v4, v5
    v_add_u32 v6, v5, v6
    v_add_u32 v7, v6, v7
    v_mov_b32 v8, v7
    s_nop 1
    v_add_u32_dpp v8, v8, v8 row_shr:1 row_mask:0xf bank_mask:0xf bound_ctrl:0
    s_nop 1
    v_add_u32_dpp v8, v8, v8 row_shr:2 row_mask:0xf bank_mask:0xf bound_ctrl:0
    s_nop 1
    v_add_u32_dpp v8, v8, v8 row_shr:4 row_mask:0xf bank_mask:0xf bound_ctrl:0
    s_nop 1
    v_add_u32_dpp v8, v8, v8 row_shr:8 row_mask:0xf bank_mask:0xf bound_ctrl:0
    s_nop 1
    v_add_u32_dpp v8, v8, v8 row_bcast:15 row_mask:0xa bank_mask:0xf
    s_nop 1
    v_add_u32_dpp v8, v8, v8 row_bcast:31 row_mask:0xc bank_mask:0xf
    s_nop 1
    v_sub_u32 v8, v8, v7
    v_add_u32 v10, v8, v5
    v_add_u32 v11, v8, v6
    v_add_u32 v5, v8, v4
    v_mov_b32 v4, v8
    v_mov_b32 v6, v10
    v_mov_b32 v7, v11
    ds_write_b128 v9, v[4:7] offset:1024
K_NOSCAN:
    s_lshl_b32 s29, s24, 10
    s_mov_b32 s58, 8192
    s_mov_b32 s59, 0x20000
    s_mov_b32 s56, s48
    s_mov_b32 s57, s49
    s_add_u32 m0, s29, 49664
    s_nop 0
    buffer_load_dwordx4 v46, s[56:59], s29 offen lds
    s_mov_b32 s56, s40
    s_mov_b32 s57, s41
    s_add_u32 m0, s29, 57856
    s_nop 0
    buffer_load_dwordx4 v46, s[56:59], s29 offen lds
    s_mov_b32 s56, s46
    s_mov_b32 s57, s47
    s_add_u32 m0, s29, 66048
    s_nop 0
    buffer_load_dwordx4 v46, s[56:59], s29 offen lds
    s_min_u32 s30, s24, 4
    s_lshl_b32 s30, s30, 10
    s_add_u32 m0, s30, 76288
    s_mul_i32 s31, s25, 5120
    s_add_u32 s30, s30, s31
    buffer_load_dwordx4 v248, s[4:7], s30 offen lds
    v_add_u32 v3, 8192, v14
    v_min_u32 v3, K_END-K_PC-16, v3
    v_mov_b32 v5, s51
    v_add_co_u32 v4, vcc, s50, v3
    s_nop 1
    v_addc_co_u32 v5, vcc, 0, v5, vcc
    global_load_dwordx4 v[116:119], v[4:5], off
    v_add_u32 v3, 16384, v14
    v_min_u32 v3, K_END-K_PC-16, v3
    v_mov_b32 v5, s51
    v_add_co_u32 v4, vcc, s50, v3
    s_nop 1
    v_addc_co_u32 v5, vcc, 0, v5, vcc
    global_load_dwordx4 v[120:123], v[4:5], off
    s_waitcnt lgkmcnt(0)
    s_barrier
    ds_read_b32 v32, v54 offset:1024
    ds_read_b32 v33, v55 offset:1024
    ds_read_b32 v34, v56 offset:1024
    ds_read_b32 v35, v57 offset:1024
    ds_read_b32 v36, v58 offset:1024
    v_lshlrev_b32 v2, 2, v250
    v_add_u32 v3, 82432, v2
    ds_read2_b32 v[8:9], v3 offset0:0 offset1:1
    s_mov_b32 s31, 84480
    s_waitcnt lgkmcnt(1)
    v_add_u32 v32, v32, v40
    v_add_u32 v33, v33, v41
    v_add_u32 v34, v34, v42
    v_add_u32 v35, v35, v43
    v_add_u32 v36, v36, v44
    v_lshl_add_u32 v32, v32, 2, s31
    v_lshl_add_u32 v33, v33, 2, s31
    v_lshl_add_u32 v34, v34, 2, s31
    v_lshl_add_u32 v35, v35, 2, s31
    v_lshl_add_u32 v36, v36, 2, s31
    ds_write_b32 v32, v48
    ds_write_b32 v33, v49
    ds_write_b32 v34, v50
    ds_write_b32 v35, v51
    ds_write_b32 v36, v52
    s_lshl_b32 s29, s25, 10
    s_waitcnt lgkmcnt(5)
    v_lshl_or_b32 v8, v9, 16, v8
    v_cmp_gt_u32 vcc, 250, v250
    s_and_saveexec_b64 s[74:75], vcc
    s_cbranch_execz K_NOP
    buffer_store_dword v8, v2, s[16:19], s29 offen sc1
K_NOP:
    s_mov_b64 exec, s[74:75]
    s_waitcnt lgkmcnt(0)
    s_barrier
    v_add_u32 v9, 84480, v14
    ds_read_b128 v[32:35], v9
    ds_read_b128 v[36:39], v9 offset:8192
    s_waitcnt lgkmcnt(1)
    buffer_store_dwordx4 v[32:35], v14, s[12:15], s33 offen sc1
    s_waitcnt lgkmcnt(0)
    v_cmp_gt_u32 vcc, 128, v250
    s_and_saveexec_b64 s[74:75], vcc
    s_cbranch_execz K_NOR
    v_add_u32 v40, 8192, v14
    buffer_store_dwordx4 v[36:39], v40, s[12:15], s33 offen sc1
K_NOR:
    s_mov_b64 exec, s[74:75]
    v_add_u32 v64, 41472, v14
    s_mov_b32 s29, 3216550459
    s_mov_b32 s30, 0xffff0000
    ds_read_b128 v[68:71], v64 offset:0
    s_waitcnt lgkmcnt(0)
    v_lshlrev_b32 v65, 16, v68
    v_and_b32 v66, s30, v68
    v_mul_f32 v65, s29, v65
    v_mul_f32 v66, s29, v66
    v_cvt_pk_bf16_f32 v68, v65, v66
    v_lshlrev_b32 v65, 16, v69
    v_and_b32 v66, s30, v69
    v_mul_f32 v65, s29, v65
    v_mul_f32 v66, s29, v66
    v_cvt_pk_bf16_f32 v69, v65, v66
    v_lshlrev_b32 v65, 16, v70
    v_and_b32 v66, s30, v70
    v_mul_f32 v65, s29, v65
    v_mul_f32 v66, s29, v66
    v_cvt_pk_bf16_f32 v70, v65, v66
    v_lshlrev_b32 v65, 16, v71
    v_and_b32 v66, s30, v71
    v_mul_f32 v65, s29, v65
    v_mul_f32 v66, s29, v66
    v_cvt_pk_bf16_f32 v71, v65, v66
    ds_write_b128 v64, v[68:71] offset:0
    v_cmp_gt_u32 vcc, 128, v250
    s_and_saveexec_b64 s[74:75], vcc
    s_cbranch_execz K_NOWC
    ds_read_b128 v[68:71], v64 offset:32768
    s_waitcnt lgkmcnt(0)
    v_lshlrev_b32 v65, 16, v68
    v_and_b32 v66, s30, v68
    v_mul_f32 v65, s29, v65
    v_mul_f32 v66, s29, v66
    v_cvt_pk_bf16_f32 v68, v65, v66
    v_lshlrev_b32 v65, 16, v69
    v_and_b32 v66, s30, v69
    v_mul_f32 v65, s29, v65
    v_mul_f32 v66, s29, v66
    v_cvt_pk_bf16_f32 v69, v65, v66
    v_lshlrev_b32 v65, 16, v70
    v_and_b32 v66, s30, v70
    v_mul_f32 v65, s29, v65
    v_mul_f32 v66, s29, v66
    v_cvt_pk_bf16_f32 v70, v65, v66
    v_lshlrev_b32 v65, 16, v71
    v_and_b32 v66, s30, v71
    v_mul_f32 v65, s29, v65
    v_mul_f32 v66, s29, v66
    v_cvt_pk_bf16_f32 v71, v65, v66
    ds_write_b128 v64, v[68:71] offset:32768
K_NOWC:
    s_mov_b64 exec, s[74:75]
    s_waitcnt vmcnt(0) lgkmcnt(0)
    s_barrier
    s_cmp_lg_u32 s24, 0
    s_cbranch_scc1 K_NOFLAG
    s_mov_b32 s29, 0x40000
K_TAGWAIT:
    v_readfirstlane_b32 s65, v29
    s_nop 3
    s_cmp_lg_u32 s65, 0
    s_cbranch_scc1 K_TAGOK
    s_sub_u32 s29, s29, 1
    s_cmp_eq_u32 s29, 0
    s_cbranch_scc1 K_TAGOK
    s_and_b32 s30, s2, 63
    s_lshl_b32 s30, s30, 2
    v_mov_b32 v10, s30
    buffer_load_dword v29, v10, s[60:63], 0 offen sc0 sc1
    s_waitcnt vmcnt(0)
    s_branch K_TAGWAIT
K_TAGOK:
    s_lshl_b32 s30, s25, 4
    s_add_u32 s30, s30, 2883584
    v_mov_b32 v10, s30
    v_mov_b32 v11, s65
    v_cmp_eq_u32 vcc, 0, v1
    s_and_saveexec_b64 s[74:75], vcc
    buffer_store_dword v11, v10, s[12:15], 0 offen sc1
    s_mov_b64 exec, s[74:75]
K_NOFLAG:
    ds_read_b128 v[80:83], v61 offset:0
    ds_read_b128 v[84:87], v61 offset:32
    ds_read_b128 v[88:91], v61 offset:64
    ds_read_b128 v[92:95], v61 offset:96
    ds_read_b128 v[100:103], v60 offset:0
    ds_read_u16 v216, v62 offset:0
    ds_read_u16 v217, v62 offset:128
    ds_read_u16 v218, v62 offset:256
    ds_read_u16 v219, v62 offset:384
    ds_read_u16 v220, v62 offset:64
    ds_read_u16 v221, v62 offset:192
    ds_read_u16 v222, v62 offset:320
    ds_read_u16 v223, v62 offset:448
    s_waitcnt lgkmcnt(4)
    ds_read_b64_tr_b16 v[16:17], v59 offset:16384
    ds_read_b64_tr_b16 v[18:19], v59 offset:16896
    ds_read_b64_tr_b16 v[20:21], v63 offset:16384
    ds_read_b64_tr_b16 v[22:23], v63 offset:16896
    ds_read_b64_tr_b16 v[24:25], v59 offset:18432
    ds_read_b64_tr_b16 v[26:27], v59 offset:18944
    ds_read_b64_tr_b16 v[28:29], v63 offset:18432
    ds_read_b64_tr_b16 v[30:31], v63 offset:18944
    s_waitcnt lgkmcnt(6)
    ds_read_b64_tr_b16 v[32:33], v59 offset:20480
    ds_read_b64_tr_b16 v[34:35], v59 offset:20992
    ds_read_b64_tr_b16 v[36:37], v63 offset:20480
    ds_read_b64_tr_b16 v[38:39], v63 offset:20992
    ds_read_b64_tr_b16 v[40:41], v59 offset:22528
    ds_read_b64_tr_b16 v[42:43], v59 offset:23040
    ds_read_b64_tr_b16 v[44:45], v63 offset:22528
    ds_read_b64_tr_b16 v[46:47], v63 offset:23040
    s_waitcnt lgkmcnt(6)
    s_waitcnt lgkmcnt(0)
    v_mfma_f32_32x32x16_bf16 v[64:79], v[80:83], v[16:19], 0
    v_mfma_f32_32x32x16_bf16 v[64:79], v[84:87], v[24:27], v[64:79]
    v_mfma_f32_32x32x16_bf16 v[64:79], v[88:91], v[32:35], v[64:79]
    v_mfma_f32_32x32x16_bf16 v[64:79], v[92:95], v[40:43], v[64:79]
    v_mfma_f32_32x32x16_bf16 v[192:207], v[80:83], v[20:23], 0
    v_mfma_f32_32x32x16_bf16 v[192:207], v[84:87], v[28:31], v[192:207]
    v_mfma_f32_32x32x16_bf16 v[192:207], v[88:91], v[36:39], v[192:207]
    v_mfma_f32_32x32x16_bf16 v[192:207], v[92:95], v[44:47], v[192:207]
    ds_read_b64_tr_b16 v[16:17], v59 offset:24576
    ds_read_b64_tr_b16 v[18:19], v59 offset:25088
    ds_read_b64_tr_b16 v[20:21], v63 offset:24576
    ds_read_b64_tr_b16 v[22:23], v63 offset:25088
    ds_read_b64_tr_b16 v[24:25], v59 offset:26624
    ds_read_b64_tr_b16 v[26:27], v59 offset:27136
    ds_read_b64_tr_b16 v[28:29], v63 offset:26624
    ds_read_b64_tr_b16 v[30:31], v63 offset:27136
    s_waitcnt lgkmcnt(6)
    ds_read_b64_tr_b16 v[32:33], v59 offset:28672
    ds_read_b64_tr_b16 v[34:35], v59 offset:29184
    ds_read_b64_tr_b16 v[36:37], v63 offset:28672
    ds_read_b64_tr_b16 v[38:39], v63 offset:29184
    ds_read_b64_tr_b16 v[40:41], v59 offset:30720
    ds_read_b64_tr_b16 v[42:43], v59 offset:31232
    ds_read_b64_tr_b16 v[44:45], v63 offset:30720
    ds_read_b64_tr_b16 v[46:47], v63 offset:31232
    s_waitcnt lgkmcnt(6)
    s_waitcnt lgkmcnt(0)
    s_nop 3
    s_mov_b32 s30, 3216550459
    v_mul_f32 v64, s30, v64
    v_mul_f32 v65, s30, v65
    v_mul_f32 v66, s30, v66
    v_mul_f32 v67, s30, v67
    v_mul_f32 v68, s30, v68
    v_mul_f32 v69, s30, v69
    v_mul_f32 v70, s30, v70
    v_mul_f32 v71, s30, v71
    v_cvt_pk_bf16_f32 v184, v64, v65
    v_cvt_pk_bf16_f32 v185, v66, v67
    v_cvt_pk_bf16_f32 v186, v68, v69
    v_cvt_pk_bf16_f32 v187, v70, v71
    v_mul_f32 v192, s30, v192
    v_mul_f32 v193, s30, v193
    v_mul_f32 v194, s30, v194
    v_mul_f32 v195, s30, v195
    v_mul_f32 v196, s30, v196
    v_mul_f32 v197, s30, v197
    v_mul_f32 v198, s30, v198
    v_mul_f32 v199, s30, v199
    v_cvt_pk_bf16_f32 v188, v192, v193
    v_cvt_pk_bf16_f32 v189, v194, v195
    v_cvt_pk_bf16_f32 v190, v196, v197
    v_cvt_pk_bf16_f32 v191, v198, v199
    v_mfma_f32_32x32x16_bf16 v[64:79], v[80:83], v[16:19], 0
    v_mfma_f32_32x32x16_bf16 v[64:79], v[84:87], v[24:27], v[64:79]
    v_mfma_f32_32x32x16_bf16 v[64:79], v[88:91], v[32:35], v[64:79]
    v_mfma_f32_32x32x16_bf16 v[64:79], v[92:95], v[40:43], v[64:79]
    v_mfma_f32_32x32x16_bf16 v[192:207], v[80:83], v[20:23], 0
    v_mfma_f32_32x32x16_bf16 v[192:207], v[84:87], v[28:31], v[192:207]
    v_mfma_f32_32x32x16_bf16 v[192:207], v[88:91], v[36:39], v[192:207]
    v_mfma_f32_32x32x16_bf16 v[192:207], v[92:95], v[44:47], v[192:207]
    s_nop 7
    s_nop 3
    v_cvt_pk_bf16_f32 v64, v64, v65
    v_cvt_pk_bf16_f32 v65, v66, v67
    v_cvt_pk_bf16_f32 v66, v68, v69
    v_cvt_pk_bf16_f32 v67, v70, v71
    v_cvt_pk_bf16_f32 v192, v192, v193
    v_cvt_pk_bf16_f32 v193, v194, v195
    v_cvt_pk_bf16_f32 v194, v196, v197
    v_cvt_pk_bf16_f32 v195, v198, v199
    s_nop 1
    v_mfma_f32_16x16x32_bf16 v[208:211], v[100:103], v[64:67], 0
    v_mfma_f32_16x16x32_bf16 v[212:215], v[100:103], v[192:195], 0
    v_lshrrev_b32 v3, 7, v248
    s_lshl_b32 s29, s24, 3
    v_add_u32 v3, s29, v3
    s_lshl_b32 s30, s25, 2
    v_lshl_add_u32 v1, v3, 10, s30
    v_mul_u32_u24 v0, 10240, v3
    v_lshlrev_b32 v7, 3, v0
    v_bfe_u32 v2, v248, 4, 3
    v_lshlrev_b32 v2, 1, v2
    v_mov_b32 v192, 0
    v_mov_b32 v193, 0
    v_mov_b32 v194, 0
    v_mov_b32 v195, 0
    v_mov_b32 v196, 0
    v_mov_b32 v197, 0
    v_mov_b32 v198, 0
    v_mov_b32 v199, 0
    v_mov_b32 v200, 0
    v_mov_b32 v201, 0
    v_mov_b32 v202, 0
    v_mov_b32 v203, 0
    v_mov_b32 v204, 0
    v_mov_b32 v205, 0
    v_mov_b32 v206, 0
    v_mov_b32 v207, 0
    s_waitcnt lgkmcnt(0)
    s_cmp_lg_u32 s24, 0
    s_cbranch_scc1 K_NOPOLL
    v_add_u32 v10, 2883584, v248
    v_add_u32 v11, 1024, v10
    v_add_u32 v12, 2048, v10
    v_add_u32 v13, 3072, v10
    v_min_u32 v13, 2887568, v13
    s_mov_b32 s29, 0x40000
    buffer_load_dword v64, v10, s[12:15], 0 offen sc1
    buffer_load_dword v65, v11, s[12:15], 0 offen sc1
    buffer_load_dword v66, v12, s[12:15], 0 offen sc1
    buffer_load_dword v67, v13, s[12:15], 0 offen sc1
    s_sleep 2
    buffer_load_dword v68, v10, s[12:15], 0 offen sc1
    buffer_load_dword v69, v11, s[12:15], 0 offen sc1
    buffer_load_dword v70, v12, s[12:15], 0 offen sc1
    buffer_load_dword v71, v13, s[12:15], 0 offen sc1
    s_sleep 2
K_POLL:
    buffer_load_dword v72, v10, s[12:15], 0 offen sc1
    buffer_load_dword v73, v11, s[12:15], 0 offen sc1
    buffer_load_dword v74, v12, s[12:15], 0 offen sc1
    buffer_load_dword v75, v13, s[12:15], 0 offen sc1
    s_waitcnt vmcnt(8)
    v_xor_b32 v64, s65, v64
    v_xor_b32 v65, s65, v65
    v_xor_b32 v66, s65, v66
    v_xor_b32 v67, s65, v67
    v_or3_b32 v64, v64, v65, v66
    v_or_b32 v64, v64, v67
    v_cmp_ne_u32 vcc, 0, v64
    s_nop 0
    s_or_b32 s30, vcc_lo, vcc_hi
    s_cmp_eq_u32 s30, 0
    s_cbranch_scc1 K_NOPOLL
    s_sleep 2
    buffer_load_dword v64, v10, s[12:15], 0 offen sc1
    buffer_load_dword v65, v11, s[12:15], 0 offen sc1
    buffer_load_dword v66, v12, s[12:15], 0 offen sc1
    buffer_load_dword v67, v13, s[12:15], 0 offen sc1
    s_waitcnt vmcnt(8)
    v_xor_b32 v68, s65, v68
    v_xor_b32 v69, s65, v69
    v_xor_b32 v70, s65, v70
    v_xor_b32 v71, s65, v71
    v_or3_b32 v68, v68, v69, v70
    v_or_b32 v68, v68, v71
    v_cmp_ne_u32 vcc, 0, v68
    s_nop 0
    s_or_b32 s30, vcc_lo, vcc_hi
    s_cmp_eq_u32 s30, 0
    s_cbranch_scc1 K_NOPOLL
    s_sleep 2
    buffer_load_dword v68, v10, s[12:15], 0 offen sc1
    buffer_load_dword v69, v11, s[12:15], 0 offen sc1
    buffer_load_dword v70, v12, s[12:15], 0 offen sc1
    buffer_load_dword v71, v13, s[12:15], 0 offen sc1
    s_waitcnt vmcnt(8)
    v_xor_b32 v72, s65, v72
    v_xor_b32 v73, s65, v73
    v_xor_b32 v74, s65, v74
    v_xor_b32 v75, s65, v75
    v_or3_b32 v72, v72, v73, v74
    v_or_b32 v72, v72, v75
    v_cmp_ne_u32 vcc, 0, v72
    s_nop 0
    s_or_b32 s30, vcc_lo, vcc_hi
    s_cmp_eq_u32 s30, 0
    s_cbranch_scc1 K_NOPOLL
    s_sleep 2
    s_sub_u32 s29, s29, 1
    s_cmp_lg_u32 s29, 0
    s_cbranch_scc1 K_POLL
K_NOPOLL:
    s_barrier
    buffer_load_dword v96, v1, s[16:19], 0 offen sc1
    v_add_u32 v105, 65536, v1
    buffer_load_dword v97, v105, s[16:19], 0 offen sc1
    v_add_u32 v106, 131072, v1
    buffer_load_dword v98, v106, s[16:19], 0 offen sc1
    v_add_u32 v107, 196608, v1
    buffer_load_dword v99, v107, s[16:19], 0 offen sc1
    ds_read_b64_tr_b16 v[112:113], v59 offset:0
    ds_read_b64_tr_b16 v[114:115], v59 offset:512
    ds_read_b64_tr_b16 v[116:117], v63 offset:0
    ds_read_b64_tr_b16 v[118:119], v63 offset:512
    ds_read_b64_tr_b16 v[120:121], v59 offset:2048
    ds_read_b64_tr_b16 v[122:123], v59 offset:2560
    ds_read_b64_tr_b16 v[124:125], v63 offset:2048
    ds_read_b64_tr_b16 v[126:127], v63 offset:2560
    s_waitcnt lgkmcnt(6)
    ds_read_b64_tr_b16 v[128:129], v59 offset:4096
    ds_read_b64_tr_b16 v[130:131], v59 offset:4608
    ds_read_b64_tr_b16 v[132:133], v63 offset:4096
    ds_read_b64_tr_b16 v[134:135], v63 offset:4608
    ds_read_b64_tr_b16 v[136:137], v59 offset:6144
    ds_read_b64_tr_b16 v[138:139], v59 offset:6656
    ds_read_b64_tr_b16 v[140:141], v63 offset:6144
    ds_read_b64_tr_b16 v[142:143], v63 offset:6656
    s_waitcnt lgkmcnt(6)
    ds_read_b64_tr_b16 v[176:177], v59 offset:32768
    ds_read_b64_tr_b16 v[178:179], v59 offset:33280
    ds_read_b64_tr_b16 v[180:181], v63 offset:32768
    ds_read_b64_tr_b16 v[182:183], v63 offset:33280
    s_waitcnt vmcnt(0)
    v_mov_b32 v6, 0
    v_and_b32 v3, 0xffff, v96
    v_lshrrev_b32 v4, 16, v96
    v_add_u32 v3, v3, v2
    s_mov_b32 s67, 0
    v_sub_u32 v4, v4, v3
    v_lshl_add_u32 v104, v3, 2, v0
    v_cmp_lt_i32 s[48:49], 16, v4
    buffer_load_dwordx2 v[16:17], v104, s[12:15], s67 offen sc1
    v_cmp_lt_i32 s[32:33], 0, v4
    v_cmp_lt_i32 s[34:35], 1, v4
    v_max_i32 v6, v6, v4
    s_cmp_eq_u64 s[48:49], 0
    s_cbranch_scc1 KF_NB0
    v_cmp_lt_i32 s[50:51], 17, v4
    s_mov_b64 exec, s[48:49]
    buffer_load_dwordx2 v[24:25], v104, s[12:15], s67 offen offset:64 sc1
    s_mov_b64 exec, -1
KF_NB0:
    v_and_b32 v3, 0xffff, v97
    v_lshrrev_b32 v4, 16, v97
    v_add_u32 v3, v3, v2
    s_mov_b32 s67, 655360
    v_sub_u32 v4, v4, v3
    v_lshl_add_u32 v105, v3, 2, v0
    v_cmp_lt_i32 s[52:53], 16, v4
    buffer_load_dwordx2 v[18:19], v105, s[12:15], s67 offen sc1
    v_cmp_lt_i32 s[36:37], 0, v4
    v_cmp_lt_i32 s[38:39], 1, v4
    v_max_i32 v6, v6, v4
    s_cmp_eq_u64 s[52:53], 0
    s_cbranch_scc1 KF_NB1
    v_cmp_lt_i32 s[54:55], 17, v4
    s_mov_b64 exec, s[52:53]
    buffer_load_dwordx2 v[26:27], v105, s[12:15], s67 offen offset:64 sc1
    s_mov_b64 exec, -1
KF_NB1:
    v_and_b32 v3, 0xffff, v98
    v_lshrrev_b32 v4, 16, v98
    v_add_u32 v3, v3, v2
    s_mov_b32 s67, 1310720
    v_sub_u32 v4, v4, v3
    v_lshl_add_u32 v106, v3, 2, v0
    v_cmp_lt_i32 s[56:57], 16, v4
    buffer_load_dwordx2 v[20:21], v106, s[12:15], s67 offen sc1
    v_cmp_lt_i32 s[40:41], 0, v4
    v_cmp_lt_i32 s[42:43], 1, v4
    v_max_i32 v6, v6, v4
    s_cmp_eq_u64 s[56:57], 0
    s_cbranch_scc1 KF_NB2
    v_cmp_lt_i32 s[58:59], 17, v4
    s_mov_b64 exec, s[56:57]
    buffer_load_dwordx2 v[28:29], v106, s[12:15], s67 offen offset:64 sc1
    s_mov_b64 exec, -1
KF_NB2:
    v_and_b32 v3, 0xffff, v99
    v_lshrrev_b32 v4, 16, v99
    v_add_u32 v3, v3, v2
    s_mov_b32 s67, 1966080
    v_sub_u32 v4, v4, v3
    v_lshl_add_u32 v107, v3, 2, v0
    v_cmp_lt_i32 s[60:61], 16, v4
    buffer_load_dwordx2 v[22:23], v107, s[12:15], s67 offen sc1
    v_cmp_lt_i32 s[44:45], 0, v4
    v_cmp_lt_i32 s[46:47], 1, v4
    v_max_i32 v6, v6, v4
    s_cmp_eq_u64 s[60:61], 0
    s_cbranch_scc1 KF_NB3
    v_cmp_lt_i32 s[62:63], 17, v4
    s_mov_b64 exec, s[60:61]
    buffer_load_dwordx2 v[30:31], v107, s[12:15], s67 offen offset:64 sc1
    s_mov_b64 exec, -1
KF_NB3:
    v_cmp_lt_i32 vcc, 32, v6
    s_nop 0
    s_or_b32 s73, vcc_lo, vcc_hi
    s_waitcnt lgkmcnt(7)
    ds_read_b64_tr_b16 v[144:145], v59 offset:8192
    ds_read_b64_tr_b16 v[146:147], v59 offset:8704
    ds_read_b64_tr_b16 v[148:149], v63 offset:8192
    ds_read_b64_tr_b16 v[150:151], v63 offset:8704
    ds_read_b64_tr_b16 v[152:153], v59 offset:10240
    ds_read_b64_tr_b16 v[154:155], v59 offset:10752
    ds_read_b64_tr_b16 v[156:157], v63 offset:10240
    ds_read_b64_tr_b16 v[158:159], v63 offset:10752
    s_waitcnt lgkmcnt(6)
    ds_read_b64_tr_b16 v[160:161], v59 offset:12288
    ds_read_b64_tr_b16 v[162:163], v59 offset:12800
    ds_read_b64_tr_b16 v[164:165], v63 offset:12288
    ds_read_b64_tr_b16 v[166:167], v63 offset:12800
    ds_read_b64_tr_b16 v[168:169], v59 offset:14336
    ds_read_b64_tr_b16 v[170:171], v59 offset:14848
    ds_read_b64_tr_b16 v[172:173], v63 offset:14336
    ds_read_b64_tr_b16 v[174:175], v63 offset:14848
    s_waitcnt lgkmcnt(6)
    s_waitcnt vmcnt(0)
    s_mov_b64 exec, s[32:33]
    v_lshrrev_b32 v3, 15, v16
    v_and_b32 v8, 0x1c, v3
    ds_add_rtn_u32 v104, v8, v249 offset:4352
    s_mov_b64 exec, s[34:35]
    v_lshrrev_b32 v3, 15, v17
    v_and_b32 v9, 0x1c, v3
    ds_add_rtn_u32 v105, v9, v249 offset:4352
    s_waitcnt lgkmcnt(1)
    s_mov_b64 exec, s[32:33]
    s_mov_b32 s67, 0
    v_min_u32 v104, 0x1ff, v104
    v_lshrrev_b32 v3, 15, v16
    v_lshlrev_b32 v4, 9, v8
    v_and_b32 v3, 0x1ffe0, v3
    v_lshl_add_u32 v4, v104, 2, v4
    v_add3_u32 v3, v3, v7, s67
    v_lshlrev_b32 v5, 4, v16
    v_and_b32 v5, 0x1ffff0, v5
    ds_write2st64_b32 v4, v5, v3 offset0:34 offset1:98
    v_lshrrev_b32 v4, 2, v4
    v_lshlrev_b32 v5, 2, v16
    v_and_b32 v5, 0x1c, v5
    v_and_or_b32 v4, v4, s71, v5
    v_lshlrev_b32 v3, v104, v249
    ds_or_b32 v4, v3 offset:4608
    s_waitcnt lgkmcnt(2)
    s_mov_b64 exec, s[34:35]
    s_mov_b32 s67, 0
    v_min_u32 v105, 0x1ff, v105
    v_lshrrev_b32 v3, 15, v17
    v_lshlrev_b32 v4, 9, v9
    v_and_b32 v3, 0x1ffe0, v3
    v_lshl_add_u32 v4, v105, 2, v4
    v_add3_u32 v3, v3, v7, s67
    v_lshlrev_b32 v5, 4, v17
    v_and_b32 v5, 0x1ffff0, v5
    ds_write2st64_b32 v4, v5, v3 offset0:34 offset1:98
    v_lshrrev_b32 v4, 2, v4
    v_lshlrev_b32 v5, 2, v17
    v_and_b32 v5, 0x1c, v5
    v_and_or_b32 v4, v4, s71, v5
    v_lshlrev_b32 v3, v105, v249
    ds_or_b32 v4, v3 offset:4608
    s_mov_b64 exec, -1
    s_waitcnt lgkmcnt(0)
    s_barrier
    s_lshl_b32 s29, s24, 2
    v_mov_b32 v48, s29
    ds_read_b32 v48, v48 offset:4352
    ds_read_b128 v[52:55], v234
    ds_read_b32 v49, v236
    ds_read_b128 v[56:59], v234 offset:128
    ds_read_b32 v50, v236 offset:128
    s_waitcnt lgkmcnt(4)
    v_readfirstlane_b32 s29, v48
    s_barrier
    s_mov_b32 s100, 0
    s_cmp_lt_u32 s29, 32
    s_cbranch_scc1 K_NOEARLY
    s_mov_b32 s100, 1
    s_waitcnt lgkmcnt(0)
    v_and_or_b32 v60, v52, s70, v228
    v_and_or_b32 v61, v53, s70, v229
    v_and_or_b32 v62, v54, s70, v230
    v_and_or_b32 v63, v55, s70, v231
    v_or_b32 v64, v49, v233
    s_add_u32 m0, s28, 0
    s_nop 0
    buffer_load_dwordx4 v60, s[4:7], 0 offen lds
    s_add_u32 m0, s28, 1024
    s_nop 0
    buffer_load_dwordx4 v61, s[4:7], 0 offen lds
    s_add_u32 m0, s28, 2048
    s_nop 0
    buffer_load_dwordx4 v62, s[4:7], 0 offen lds
    s_add_u32 m0, s28, 3072
    s_nop 0
    buffer_load_dwordx4 v63, s[4:7], 0 offen lds
    s_add_u32 m0, s28, 4096
    s_nop 0
    buffer_load_dwordx4 v64, s[8:11], 0 offen lds
K_NOEARLY:
    s_mov_b64 exec, s[36:37]
    v_lshrrev_b32 v3, 15, v18
    v_and_b32 v10, 0x1c, v3
    ds_add_rtn_u32 v106, v10, v249 offset:4352
    s_mov_b64 exec, s[38:39]
    v_lshrrev_b32 v3, 15, v19
    v_and_b32 v11, 0x1c, v3
    ds_add_rtn_u32 v107, v11, v249 offset:4352
    s_mov_b64 exec, s[40:41]
    v_lshrrev_b32 v3, 15, v20
    v_and_b32 v12, 0x1c, v3
    ds_add_rtn_u32 v108, v12, v249 offset:4352
    s_mov_b64 exec, s[42:43]
    v_lshrrev_b32 v3, 15, v21
    v_and_b32 v13, 0x1c, v3
    ds_add_rtn_u32 v109, v13, v249 offset:4352
    s_mov_b64 exec, s[44:45]
    v_lshrrev_b32 v3, 15, v22
    v_and_b32 v14, 0x1c, v3
    ds_add_rtn_u32 v110, v14, v249 offset:4352
    s_mov_b64 exec, s[46:47]
    v_lshrrev_b32 v3, 15, v23
    v_and_b32 v15, 0x1c, v3
    ds_add_rtn_u32 v111, v15, v249 offset:4352
    s_waitcnt lgkmcnt(5)
    s_mov_b64 exec, s[36:37]
    s_mov_b32 s67, 5242880
    v_min_u32 v106, 0x1ff, v106
    v_lshrrev_b32 v3, 15, v18
    v_lshlrev_b32 v4, 9, v10
    v_and_b32 v3, 0x1ffe0, v3
    v_lshl_add_u32 v4, v106, 2, v4
    v_add3_u32 v3, v3, v7, s67
    v_lshlrev_b32 v5, 4, v18
    v_and_b32 v5, 0x1ffff0, v5
    ds_write2st64_b32 v4, v5, v3 offset0:34 offset1:98
    v_lshrrev_b32 v4, 2, v4
    v_lshlrev_b32 v5, 2, v18
    v_and_b32 v5, 0x1c, v5
    v_and_or_b32 v4, v4, s71, v5
    v_lshlrev_b32 v3, v106, v249
    ds_or_b32 v4, v3 offset:4608
    s_waitcnt lgkmcnt(6)
    s_mov_b64 exec, s[38:39]
    s_mov_b32 s67, 5242880
    v_min_u32 v107, 0x1ff, v107
    v_lshrrev_b32 v3, 15, v19
    v_lshlrev_b32 v4, 9, v11
    v_and_b32 v3, 0x1ffe0, v3
    v_lshl_add_u32 v4, v107, 2, v4
    v_add3_u32 v3, v3, v7, s67
    v_lshlrev_b32 v5, 4, v19
    v_and_b32 v5, 0x1ffff0, v5
    ds_write2st64_b32 v4, v5, v3 offset0:34 offset1:98
    v_lshrrev_b32 v4, 2, v4
    v_lshlrev_b32 v5, 2, v19
    v_and_b32 v5, 0x1c, v5
    v_and_or_b32 v4, v4, s71, v5
    v_lshlrev_b32 v3, v107, v249
    ds_or_b32 v4, v3 offset:4608
    s_waitcnt lgkmcnt(7)
    s_mov_b64 exec, s[40:41]
    s_mov_b32 s67, 10485760
    v_min_u32 v108, 0x1ff, v108
    v_lshrrev_b32 v3, 15, v20
    v_lshlrev_b32 v4, 9, v12
    v_and_b32 v3, 0x1ffe0, v3
    v_lshl_add_u32 v4, v108, 2, v4
    v_add3_u32 v3, v3, v7, s67
    v_lshlrev_b32 v5, 4, v20
    v_and_b32 v5, 0x1ffff0, v5
    ds_write2st64_b32 v4, v5, v3 offset0:34 offset1:98
    v_lshrrev_b32 v4, 2, v4
    v_lshlrev_b32 v5, 2, v20
    v_and_b32 v5, 0x1c, v5
    v_and_or_b32 v4, v4, s71, v5
    v_lshlrev_b32 v3, v108, v249
    ds_or_b32 v4, v3 offset:4608
    s_waitcnt lgkmcnt(8)
    s_mov_b64 exec, s[42:43]
    s_mov_b32 s67, 10485760
    v_min_u32 v109, 0x1ff, v109
    v_lshrrev_b32 v3, 15, v21
    v_lshlrev_b32 v4, 9, v13
    v_and_b32 v3, 0x1ffe0, v3
    v_lshl_add_u32 v4, v109, 2, v4
    v_add3_u32 v3, v3, v7, s67
    v_lshlrev_b32 v5, 4, v21
    v_and_b32 v5, 0x1ffff0, v5
    ds_write2st64_b32 v4, v5, v3 offset0:34 offset1:98
    v_lshrrev_b32 v4, 2, v4
    v_lshlrev_b32 v5, 2, v21
    v_and_b32 v5, 0x1c, v5
    v_and_or_b32 v4, v4, s71, v5
    v_lshlrev_b32 v3, v109, v249
    ds_or_b32 v4, v3 offset:4608
    s_waitcnt lgkmcnt(7)
    s_mov_b64 exec, s[44:45]
    s_mov_b32 s67, 15728640
    v_min_u32 v110, 0x1ff, v110
    v_lshrrev_b32 v3, 15, v22
    v_lshlrev_b32 v4, 9, v14
    v_and_b32 v3, 0x1ffe0, v3
    v_lshl_add_u32 v4, v110, 2, v4
    v_add3_u32 v3, v3, v7, s67
    v_lshlrev_b32 v5, 4, v22
    v_and_b32 v5, 0x1ffff0, v5
    ds_write2st64_b32 v4, v5, v3 offset0:34 offset1:98
    v_lshrrev_b32 v4, 2, v4
    v_lshlrev_b32 v5, 2, v22
    v_and_b32 v5, 0x1c, v5
    v_and_or_b32 v4, v4, s71, v5
    v_lshlrev_b32 v3, v110, v249
    ds_or_b32 v4, v3 offset:4608
    s_waitcnt lgkmcnt(6)
    s_mov_b64 exec, s[46:47]
    s_mov_b32 s67, 15728640
    v_min_u32 v111, 0x1ff, v111
    v_lshrrev_b32 v3, 15, v23
    v_lshlrev_b32 v4, 9, v15
    v_and_b32 v3, 0x1ffe0, v3
    v_lshl_add_u32 v4, v111, 2, v4
    v_add3_u32 v3, v3, v7, s67
    v_lshlrev_b32 v5, 4, v23
    v_and_b32 v5, 0x1ffff0, v5
    ds_write2st64_b32 v4, v5, v3 offset0:34 offset1:98
    v_lshrrev_b32 v4, 2, v4
    v_lshlrev_b32 v5, 2, v23
    v_and_b32 v5, 0x1c, v5
    v_and_or_b32 v4, v4, s71, v5
    v_lshlrev_b32 v3, v111, v249
    ds_or_b32 v4, v3 offset:4608
    s_mov_b64 exec, -1
    s_cmp_lg_u64 s[48:49], 0
    s_cbranch_scc1 KF_HB0
KF_RB0:
    s_cmp_lg_u64 s[52:53], 0
    s_cbranch_scc1 KF_HB1
KF_RB1:
    s_cmp_lg_u64 s[56:57], 0
    s_cbranch_scc1 KF_HB2
KF_RB2:
    s_cmp_lg_u64 s[60:61], 0
    s_cbranch_scc1 KF_HB3
KF_RB3:
    s_cmp_lg_u32 s73, 0
    s_cbranch_scc1 KF_MORE
KF_DONE:
    s_waitcnt lgkmcnt(0)
    s_barrier
K_SETUP:
    v_mov_b32 v12, 0
    ds_read_b128 v[0:3], v12 offset:4352
    ds_read_b128 v[4:7], v12 offset:4368
    s_lshl_b32 s29, s24, 2
    v_mov_b32 v13, s29
    ds_read_b32 v14, v13 offset:4352
    v_lshrrev_b32 v12, 4, v248
    s_lshl_b32 s29, s24, 9
    v_mov_b32 v10, 0x7ffffff0
    v_mov_b32 v11, 0x7fffffe0
    s_waitcnt lgkmcnt(0)
    v_readfirstlane_b32 s26, v14
    v_max3_u32 v0, v0, v1, v2
    v_max3_u32 v0, v0, v3, v4
    v_max3_u32 v0, v0, v5, v6
    v_max_u32 v0, v0, v7
    v_add_u32 v12, s26, v12
    v_readfirstlane_b32 s30, v0
    v_cmp_gt_u32 vcc, 512, v12
    s_and_saveexec_b64 s[74:75], vcc
    v_add_lshl_u32 v13, v12, s29, 2
    ds_write2st64_b32 v13, v10, v11 offset0:34 offset1:98
    s_mov_b64 exec, s[74:75]
    v_add_u32 v12, 64, v12
    v_cmp_gt_u32 vcc, 512, v12
    s_and_saveexec_b64 s[74:75], vcc
    v_add_lshl_u32 v13, v12, s29, 2
    ds_write2st64_b32 v13, v10, v11 offset0:34 offset1:98
    s_mov_b64 exec, s[74:75]
    v_add_u32 v12, 64, v12
    s_cmp_gt_u32 s30, 416
    s_cbranch_scc1 K_OVER
    ds_read_b128 v[0:3], v234
    ds_read_b32 v4, v236
    ds_read_b128 v[96:99], v234 offset:128
    ds_read_b32 v7, v236 offset:128
    ds_read_b128 v[104:107], v234 offset:256
    ds_read_b32 v108, v236 offset:256
    ds_read_b32 v6, v237
    ds_read_b32 v5, v235
    ds_read_b32 v109, v235 offset:128
    s_sub_u32 s101, s26, 1
    s_and_b32 s101, s101, 16
    s_add_u32 s26, s26, 31
    s_lshr_b32 s26, s26, 5
    s_cmp_eq_u32 s100, 0
    s_cbranch_scc1 K_LATE
K_LATERET:
    s_waitcnt lgkmcnt(0)
    s_waitcnt lgkmcnt(0)
    v_mov_b32 v0, v96
    v_mov_b32 v1, v97
    v_mov_b32 v2, v98
    v_mov_b32 v3, v99
    v_mov_b32 v4, v7
    v_and_or_b32 v8, v0, s70, v228
    v_and_or_b32 v9, v1, s70, v229
    v_and_or_b32 v10, v2, s70, v230
    v_and_or_b32 v11, v3, s70, v231
    v_or_b32 v12, v4, v233
    s_add_u32 m0, s28, 5120
    s_nop 0
    buffer_load_dwordx4 v8, s[4:7], 0 offen lds
    s_add_u32 m0, s28, 6144
    s_nop 0
    buffer_load_dwordx4 v9, s[4:7], 0 offen lds
    s_add_u32 m0, s28, 7168
    s_nop 0
    buffer_load_dwordx4 v10, s[4:7], 0 offen lds
    s_add_u32 m0, s28, 8192
    s_nop 0
    buffer_load_dwordx4 v11, s[4:7], 0 offen lds
    s_add_u32 m0, s28, 9216
    s_nop 0
    buffer_load_dwordx4 v12, s[8:11], 0 offen lds
    v_mov_b32 v253, s26
    ds_write_b32 v251, v253
    v_mov_b32 v0, v104
    v_mov_b32 v1, v105
    v_mov_b32 v2, v106
    v_mov_b32 v3, v107
    v_mov_b32 v4, v108
    v_and_or_b32 v15, v5, s72, v241
    ds_read_b128 v[100:103], v15 offset:4096
    v_and_or_b32 v15, v109, s72, v241
    v_and_or_b32 v8, v0, s70, v228
    v_and_or_b32 v9, v1, s70, v229
    v_and_or_b32 v10, v2, s70, v230
    v_and_or_b32 v11, v3, s70, v231
    v_or_b32 v12, v4, v233
    v_alignbit_b32 v13, v6, v6, v238
    v_alignbit_b32 v14, v6, v6, v239
    v_and_b32 v13, v13, v240
    v_and_b32 v14, v14, v240
    ds_read_b128 v[104:107], v13 offset:0
    v_mov_b32 v52, 0
    v_mov_b32 v68, 0
    v_mov_b32 v108, 0
    v_mov_b32 v53, 0
    v_mov_b32 v69, 0
    v_mov_b32 v109, 0
    v_mov_b32 v54, 0
    v_mov_b32 v70, 0
    v_mov_b32 v110, 0
    v_mov_b32 v55, 0
    v_mov_b32 v71, 0
    v_mov_b32 v111, 0
    s_waitcnt vmcnt(5)
    ds_read_b128 v[80:83], v224
    ds_read_b128 v[84:87], v225
    ds_read_b128 v[88:91], v226
    ds_read_b128 v[92:95], v227
    ds_read_b128 v[96:99], v232
    s_waitcnt lgkmcnt(0)
    s_add_u32 m0, s28, 0
    s_nop 0
    buffer_load_dwordx4 v8, s[4:7], 0 offen lds
    s_add_u32 m0, s28, 1024
    s_nop 0
    buffer_load_dwordx4 v9, s[4:7], 0 offen lds
    s_add_u32 m0, s28, 2048
    s_nop 0
    buffer_load_dwordx4 v10, s[4:7], 0 offen lds
    s_add_u32 m0, s28, 3072
    s_nop 0
    buffer_load_dwordx4 v11, s[4:7], 0 offen lds
    s_add_u32 m0, s28, 4096
    s_nop 0
    buffer_load_dwordx4 v12, s[8:11], 0 offen lds
    v_mfma_f32_32x32x16_bf16 v[16:31], v[100:103], v[184:187], 0
    v_mfma_f32_32x32x16_bf16 v[16:31], v[96:99], v[176:179], v[16:31]
    v_mfma_f32_32x32x16_bf16 v[16:31], v[80:83], v[112:115], v[16:31]
    v_mfma_f32_32x32x16_bf16 v[32:47], v[80:83], v[144:147], 0
    v_mfma_f32_32x32x16_bf16 v[16:31], v[84:87], v[120:123], v[16:31]
    v_mfma_f32_32x32x16_bf16 v[32:47], v[84:87], v[152:155], v[32:47]
    v_mfma_f32_32x32x16_bf16 v[16:31], v[88:91], v[128:131], v[16:31]
    v_mfma_f32_32x32x16_bf16 v[32:47], v[88:91], v[160:163], v[32:47]
    v_mfma_f32_32x32x16_bf16 v[16:31], v[92:95], v[136:139], v[16:31]
    v_mfma_f32_32x32x16_bf16 v[32:47], v[92:95], v[168:171], v[32:47]
    s_sub_u32 s27, s26, 1
    s_nop 7
    s_nop 3
    s_cmp_eq_u32 s26, 0
    s_cbranch_scc1 K_LOOPEND
    s_cmp_eq_u32 s26, 1
    s_cbranch_scc1 K_FINAL
.balignl 64, 0xBF800000
K_LOOP:
    s_waitcnt vmcnt(5)
    v_exp_f32 v16, v16
    v_exp_f32 v17, v17
    v_mfma_f32_16x16x32_bf16 v[196:199], v[108:111], v[52:55], v[196:199]
    v_mfma_f32_16x16x32_bf16 v[204:207], v[108:111], v[68:71], v[204:207]
    ds_read_b128 v[108:111], v14 offset:0
    v_exp_f32 v18, v18
    v_exp_f32 v19, v19
    v_mfma_f32_32x32x16_bf16 v[48:63], v[100:103], v[188:191], 0
    ds_read_b128 v[100:103], v15 offset:4096
    v_exp_f32 v20, v20
    v_exp_f32 v21, v21
    v_exp_f32 v22, v22
    v_exp_f32 v23, v23
    v_add_f32 v16, 1.0, v16
    v_add_f32 v17, 1.0, v17
    v_mfma_f32_32x32x16_bf16 v[48:63], v[96:99], v[180:183], v[48:63]
    ds_read_b128 v[96:99], v232 offset:5120
    v_add_f32 v18, 1.0, v18
    v_add_f32 v19, 1.0, v19
    v_add_f32 v20, 1.0, v20
    v_add_f32 v21, 1.0, v21
    v_add_f32 v22, 1.0, v22
    v_add_f32 v23, 1.0, v23
    v_mfma_f32_32x32x16_bf16 v[48:63], v[80:83], v[116:119], v[48:63]
    ds_read_b32 v6, v237 offset:32
    v_rcp_f32 v16, v16
    v_rcp_f32 v17, v17
    v_rcp_f32 v18, v18
    v_rcp_f32 v19, v19
    v_rcp_f32 v20, v20
    v_rcp_f32 v21, v21
    v_mfma_f32_32x32x16_bf16 v[64:79], v[80:83], v[148:151], 0
    ds_read_b128 v[80:83], v224 offset:5120
    v_rcp_f32 v22, v22
    v_rcp_f32 v23, v23
    v_mul_f32 v32, v32, v16
    v_mul_f32 v33, v33, v17
    v_mul_f32 v34, v34, v18
    v_mul_f32 v35, v35, v19
    v_mfma_f32_32x32x16_bf16 v[48:63], v[84:87], v[124:127], v[48:63]
    ds_read_b128 v[0:3], v234 offset:384
    v_mul_f32 v36, v36, v20
    v_mul_f32 v37, v37, v21
    v_mul_f32 v38, v38, v22
    v_mul_f32 v39, v39, v23
    v_cvt_pk_bf16_f32 v16, v16, v17
    v_cvt_pk_bf16_f32 v17, v18, v19
    v_mfma_f32_32x32x16_bf16 v[64:79], v[84:87], v[156:159], v[64:79]
    ds_read_b128 v[84:87], v225 offset:5120
    v_cvt_pk_bf16_f32 v18, v20, v21
    v_cvt_pk_bf16_f32 v19, v22, v23
    v_cvt_pk_bf16_f32 v32, v32, v33
    v_cvt_pk_bf16_f32 v33, v34, v35
    v_cvt_pk_bf16_f32 v34, v36, v37
    v_cvt_pk_bf16_f32 v35, v38, v39
    v_mfma_f32_32x32x16_bf16 v[48:63], v[88:91], v[132:135], v[48:63]
    ds_read_b32 v4, v236 offset:384
    v_exp_f32 v24, v24
    v_exp_f32 v25, v25
    s_waitcnt lgkmcnt(8)
    v_mfma_f32_16x16x32_bf16 v[192:195], v[104:107], v[16:19], v[192:195]
    v_mfma_f32_16x16x32_bf16 v[200:203], v[104:107], v[32:35], v[200:203]
    v_exp_f32 v26, v26
    v_exp_f32 v27, v27
    v_exp_f32 v28, v28
    v_exp_f32 v29, v29
    v_mfma_f32_32x32x16_bf16 v[64:79], v[88:91], v[164:167], v[64:79]
    ds_read_b128 v[88:91], v226 offset:5120
    v_exp_f32 v30, v30
    v_exp_f32 v31, v31
    v_add_f32 v24, 1.0, v24
    v_add_f32 v25, 1.0, v25
    v_add_f32 v26, 1.0, v26
    v_add_f32 v27, 1.0, v27
    v_mfma_f32_32x32x16_bf16 v[48:63], v[92:95], v[140:143], v[48:63]
    ds_read_b32 v253, v252
    v_add_f32 v28, 1.0, v28
    v_add_f32 v29, 1.0, v29
    v_add_f32 v30, 1.0, v30
    v_add_f32 v31, 1.0, v31
    v_rcp_f32 v24, v24
    v_rcp_f32 v25, v25
    v_mfma_f32_32x32x16_bf16 v[64:79], v[92:95], v[172:175], v[64:79]
    ds_read_b128 v[92:95], v227 offset:5120
    v_rcp_f32 v26, v26
    v_rcp_f32 v27, v27
    v_rcp_f32 v28, v28
    v_rcp_f32 v29, v29
    v_rcp_f32 v30, v30
    v_rcp_f32 v31, v31
    v_mul_f32 v40, v40, v24
    v_mul_f32 v41, v41, v25
    v_mul_f32 v42, v42, v26
    v_mul_f32 v43, v43, v27
    v_mul_f32 v44, v44, v28
    v_mul_f32 v45, v45, v29
    v_mul_f32 v46, v46, v30
    v_mul_f32 v47, v47, v31
    v_cvt_pk_bf16_f32 v20, v24, v25
    v_cvt_pk_bf16_f32 v21, v26, v27
    v_cvt_pk_bf16_f32 v22, v28, v29
    v_cvt_pk_bf16_f32 v23, v30, v31
    v_cvt_pk_bf16_f32 v36, v40, v41
    v_cvt_pk_bf16_f32 v37, v42, v43
    v_cvt_pk_bf16_f32 v38, v44, v45
    v_cvt_pk_bf16_f32 v39, v46, v47
    v_exp_f32 v48, v48
    v_exp_f32 v49, v49
    s_waitcnt lgkmcnt(10)
    v_mfma_f32_16x16x32_bf16 v[192:195], v[108:111], v[20:23], v[192:195]
    v_mfma_f32_16x16x32_bf16 v[200:203], v[108:111], v[36:39], v[200:203]
    v_exp_f32 v50, v50
    v_exp_f32 v51, v51
    s_waitcnt lgkmcnt(9)
    v_mfma_f32_32x32x16_bf16 v[16:31], v[100:103], v[184:187], 0
    ds_read_b32 v5, v235 offset:256
    s_waitcnt lgkmcnt(2)
    v_readfirstlane_b32 s99, v253
    v_exp_f32 v52, v52
    v_exp_f32 v53, v53
    v_exp_f32 v54, v54
    v_exp_f32 v55, v55
    s_add_u32 s67, s27, s98
    s_cmp_gt_u32 s67, s99
    s_setprio 0
    s_cbranch_scc0 K_PR0
    s_setprio 1
K_PR0:
    v_add_f32 v48, 1.0, v48
    v_add_f32 v49, 1.0, v49
    v_mfma_f32_32x32x16_bf16 v[16:31], v[96:99], v[176:179], v[16:31]
    v_and_or_b32 v8, v0, s70, v228
    v_and_or_b32 v9, v1, s70, v229
    v_and_or_b32 v10, v2, s70, v230
    v_add_f32 v50, 1.0, v50
    v_add_f32 v51, 1.0, v51
    v_add_f32 v52, 1.0, v52
    v_add_f32 v53, 1.0, v53
    v_add_f32 v54, 1.0, v54
    v_add_f32 v55, 1.0, v55
    v_mfma_f32_32x32x16_bf16 v[16:31], v[80:83], v[112:115], v[16:31]
    v_and_or_b32 v11, v3, s70, v231
    v_or_b32 v12, v4, v233
    v_alignbit_b32 v13, v6, v6, v238
    v_alignbit_b32 v14, v6, v6, v239
    v_rcp_f32 v48, v48
    v_rcp_f32 v49, v49
    v_rcp_f32 v50, v50
    v_rcp_f32 v51, v51
    v_rcp_f32 v52, v52
    v_rcp_f32 v53, v53
    v_mfma_f32_32x32x16_bf16 v[32:47], v[80:83], v[144:147], 0
    v_and_b32 v13, v13, v240
    v_and_b32 v14, v14, v240
    v_rcp_f32 v54, v54
    v_rcp_f32 v55, v55
    v_mul_f32 v64, v64, v48
    v_mul_f32 v65, v65, v49
    v_mul_f32 v66, v66, v50
    s_add_u32 m0, s28, 5120
    v_mul_f32 v67, v67, v51
    v_mfma_f32_32x32x16_bf16 v[16:31], v[84:87], v[120:123], v[16:31]
    s_waitcnt lgkmcnt(1)
    buffer_load_dwordx4 v8, s[4:7], 0 offen lds
    v_mul_f32 v68, v68, v52
    v_mul_f32 v69, v69, v53
    v_mul_f32 v70, v70, v54
    v_mul_f32 v71, v71, v55
    v_cvt_pk_bf16_f32 v48, v48, v49
    s_add_u32 m0, s28, 6144
    v_cvt_pk_bf16_f32 v49, v50, v51
    v_mfma_f32_32x32x16_bf16 v[32:47], v[84:87], v[152:155], v[32:47]
    buffer_load_dwordx4 v9, s[4:7], 0 offen lds
    v_cvt_pk_bf16_f32 v50, v52, v53
    v_cvt_pk_bf16_f32 v51, v54, v55
    v_cvt_pk_bf16_f32 v64, v64, v65
    v_cvt_pk_bf16_f32 v65, v66, v67
    v_cvt_pk_bf16_f32 v66, v68, v69
    s_add_u32 m0, s28, 7168
    v_cvt_pk_bf16_f32 v67, v70, v71
    v_mfma_f32_32x32x16_bf16 v[16:31], v[88:91], v[128:131], v[16:31]
    buffer_load_dwordx4 v10, s[4:7], 0 offen lds
    v_exp_f32 v56, v56
    v_exp_f32 v57, v57
    v_mfma_f32_16x16x32_bf16 v[196:199], v[104:107], v[48:51], v[196:199]
    v_mfma_f32_16x16x32_bf16 v[204:207], v[104:107], v[64:67], v[204:207]
    v_exp_f32 v58, v58
    ds_read_b128 v[104:107], v13 offset:0
    v_exp_f32 v59, v59
    v_exp_f32 v60, v60
    s_add_u32 m0, s28, 8192
    v_exp_f32 v61, v61
    v_mfma_f32_32x32x16_bf16 v[32:47], v[88:91], v[160:163], v[32:47]
    buffer_load_dwordx4 v11, s[4:7], 0 offen lds
    v_exp_f32 v62, v62
    v_exp_f32 v63, v63
    v_add_f32 v56, 1.0, v56
    v_add_f32 v57, 1.0, v57
    v_add_f32 v58, 1.0, v58
    s_add_u32 m0, s28, 9216
    v_add_f32 v59, 1.0, v59
    v_mfma_f32_32x32x16_bf16 v[16:31], v[92:95], v[136:139], v[16:31]
    buffer_load_dwordx4 v12, s[8:11], 0 offen lds
    s_waitcnt lgkmcnt(1)
    v_and_or_b32 v15, v5, s72, v241
    v_add_f32 v60, 1.0, v60
    v_add_f32 v61, 1.0, v61
    v_add_f32 v62, 1.0, v62
    v_add_f32 v63, 1.0, v63
    v_rcp_f32 v56, v56
    v_rcp_f32 v57, v57
    v_mfma_f32_32x32x16_bf16 v[32:47], v[92:95], v[168:171], v[32:47]
    v_mov_b32 v253, s27
    v_add_u32 v253, -1, v253
    ds_write_b32 v251, v253
    v_rcp_f32 v58, v58
    v_rcp_f32 v59, v59
    v_rcp_f32 v60, v60
    v_rcp_f32 v61, v61
    v_rcp_f32 v62, v62
    v_rcp_f32 v63, v63
    v_mul_f32 v72, v72, v56
    v_mul_f32 v73, v73, v57
    v_mul_f32 v74, v74, v58
    v_mul_f32 v75, v75, v59
    v_mul_f32 v76, v76, v60
    v_mul_f32 v77, v77, v61
    v_mul_f32 v78, v78, v62
    v_mul_f32 v79, v79, v63
    v_cvt_pk_bf16_f32 v52, v56, v57
    v_cvt_pk_bf16_f32 v53, v58, v59
    v_cvt_pk_bf16_f32 v54, v60, v61
    v_cvt_pk_bf16_f32 v55, v62, v63
    v_cvt_pk_bf16_f32 v68, v72, v73
    v_cvt_pk_bf16_f32 v69, v74, v75
    v_cvt_pk_bf16_f32 v70, v76, v77
    v_cvt_pk_bf16_f32 v71, v78, v79
    s_sub_u32 s27, s27, 1
    s_cmp_eq_u32 s27, 0
    s_cbranch_scc1 K_FINAL
    s_waitcnt vmcnt(5)
    v_exp_f32 v16, v16
    v_exp_f32 v17, v17
    v_mfma_f32_16x16x32_bf16 v[196:199], v[108:111], v[52:55], v[196:199]
    v_mfma_f32_16x16x32_bf16 v[204:207], v[108:111], v[68:71], v[204:207]
    ds_read_b128 v[108:111], v14 offset:0
    v_exp_f32 v18, v18
    v_exp_f32 v19, v19
    v_mfma_f32_32x32x16_bf16 v[48:63], v[100:103], v[188:191], 0
    ds_read_b128 v[100:103], v15 offset:4096
    v_exp_f32 v20, v20
    v_exp_f32 v21, v21
    v_exp_f32 v22, v22
    v_exp_f32 v23, v23
    v_add_f32 v16, 1.0, v16
    v_add_f32 v17, 1.0, v17
    v_mfma_f32_32x32x16_bf16 v[48:63], v[96:99], v[180:183], v[48:63]
    ds_read_b128 v[96:99], v232 offset:0
    v_add_f32 v18, 1.0, v18
    v_add_f32 v19, 1.0, v19
    v_add_f32 v20, 1.0, v20
    v_add_f32 v21, 1.0, v21
    v_add_f32 v22, 1.0, v22
    v_add_f32 v23, 1.0, v23
    v_mfma_f32_32x32x16_bf16 v[48:63], v[80:83], v[116:119], v[48:63]
    ds_read_b32 v6, v237 offset:64
    v_rcp_f32 v16, v16
    v_rcp_f32 v17, v17
    v_rcp_f32 v18, v18
    v_rcp_f32 v19, v19
    v_rcp_f32 v20, v20
    v_rcp_f32 v21, v21
    v_mfma_f32_32x32x16_bf16 v[64:79], v[80:83], v[148:151], 0
    ds_read_b128 v[80:83], v224 offset:0
    v_rcp_f32 v22, v22
    v_rcp_f32 v23, v23
    v_mul_f32 v32, v32, v16
    v_mul_f32 v33, v33, v17
    v_mul_f32 v34, v34, v18
    v_mul_f32 v35, v35, v19
    v_mfma_f32_32x32x16_bf16 v[48:63], v[84:87], v[124:127], v[48:63]
    ds_read_b128 v[0:3], v234 offset:512
    v_mul_f32 v36, v36, v20
    v_mul_f32 v37, v37, v21
    v_mul_f32 v38, v38, v22
    v_mul_f32 v39, v39, v23
    v_cvt_pk_bf16_f32 v16, v16, v17
    v_cvt_pk_bf16_f32 v17, v18, v19
    v_mfma_f32_32x32x16_bf16 v[64:79], v[84:87], v[156:159], v[64:79]
    ds_read_b128 v[84:87], v225 offset:0
    v_cvt_pk_bf16_f32 v18, v20, v21
    v_cvt_pk_bf16_f32 v19, v22, v23
    v_cvt_pk_bf16_f32 v32, v32, v33
    v_cvt_pk_bf16_f32 v33, v34, v35
    v_cvt_pk_bf16_f32 v34, v36, v37
    v_cvt_pk_bf16_f32 v35, v38, v39
    v_mfma_f32_32x32x16_bf16 v[48:63], v[88:91], v[132:135], v[48:63]
    ds_read_b32 v4, v236 offset:512
    v_exp_f32 v24, v24
    v_exp_f32 v25, v25
    s_waitcnt lgkmcnt(9)
    v_mfma_f32_16x16x32_bf16 v[192:195], v[104:107], v[16:19], v[192:195]
    v_mfma_f32_16x16x32_bf16 v[200:203], v[104:107], v[32:35], v[200:203]
    v_exp_f32 v26, v26
    v_exp_f32 v27, v27
    v_exp_f32 v28, v28
    v_exp_f32 v29, v29
    v_mfma_f32_32x32x16_bf16 v[64:79], v[88:91], v[164:167], v[64:79]
    ds_read_b128 v[88:91], v226 offset:0
    v_exp_f32 v30, v30
    v_exp_f32 v31, v31
    v_add_f32 v24, 1.0, v24
    v_add_f32 v25, 1.0, v25
    v_add_f32 v26, 1.0, v26
    v_add_f32 v27, 1.0, v27
    v_mfma_f32_32x32x16_bf16 v[48:63], v[92:95], v[140:143], v[48:63]
    v_add_f32 v28, 1.0, v28
    v_add_f32 v29, 1.0, v29
    v_add_f32 v30, 1.0, v30
    v_add_f32 v31, 1.0, v31
    v_rcp_f32 v24, v24
    v_rcp_f32 v25, v25
    v_mfma_f32_32x32x16_bf16 v[64:79], v[92:95], v[172:175], v[64:79]
    ds_read_b128 v[92:95], v227 offset:0
    v_rcp_f32 v26, v26
    v_rcp_f32 v27, v27
    v_rcp_f32 v28, v28
    v_rcp_f32 v29, v29
    v_rcp_f32 v30, v30
    v_rcp_f32 v31, v31
    v_mul_f32 v40, v40, v24
    v_mul_f32 v41, v41, v25
    v_mul_f32 v42, v42, v26
    v_mul_f32 v43, v43, v27
    v_mul_f32 v44, v44, v28
    v_mul_f32 v45, v45, v29
    v_mul_f32 v46, v46, v30
    v_mul_f32 v47, v47, v31
    v_cvt_pk_bf16_f32 v20, v24, v25
    v_cvt_pk_bf16_f32 v21, v26, v27
    v_cvt_pk_bf16_f32 v22, v28, v29
    v_cvt_pk_bf16_f32 v23, v30, v31
    v_cvt_pk_bf16_f32 v36, v40, v41
    v_cvt_pk_bf16_f32 v37, v42, v43
    v_cvt_pk_bf16_f32 v38, v44, v45
    v_cvt_pk_bf16_f32 v39, v46, v47
    v_exp_f32 v48, v48
    v_exp_f32 v49, v49
    s_waitcnt lgkmcnt(9)
    v_mfma_f32_16x16x32_bf16 v[192:195], v[108:111], v[20:23], v[192:195]
    v_mfma_f32_16x16x32_bf16 v[200:203], v[108:111], v[36:39], v[200:203]
    v_exp_f32 v50, v50
    v_exp_f32 v51, v51
    s_waitcnt lgkmcnt(8)
    v_mfma_f32_32x32x16_bf16 v[16:31], v[100:103], v[184:187], 0
    ds_read_b32 v5, v235 offset:384
    v_exp_f32 v52, v52
    v_exp_f32 v53, v53
    v_exp_f32 v54, v54
    v_exp_f32 v55, v55
    v_add_f32 v48, 1.0, v48
    v_add_f32 v49, 1.0, v49
    s_waitcnt lgkmcnt(8)
    v_mfma_f32_32x32x16_bf16 v[16:31], v[96:99], v[176:179], v[16:31]
    s_waitcnt lgkmcnt(5)
    v_and_or_b32 v8, v0, s70, v228
    v_and_or_b32 v9, v1, s70, v229
    v_and_or_b32 v10, v2, s70, v230
    v_add_f32 v50, 1.0, v50
    v_add_f32 v51, 1.0, v51
    v_add_f32 v52, 1.0, v52
    v_add_f32 v53, 1.0, v53
    v_add_f32 v54, 1.0, v54
    v_add_f32 v55, 1.0, v55
    v_mfma_f32_32x32x16_bf16 v[16:31], v[80:83], v[112:115], v[16:31]
    v_and_or_b32 v11, v3, s70, v231
    s_waitcnt lgkmcnt(3)
    v_or_b32 v12, v4, v233
    v_alignbit_b32 v13, v6, v6, v238
    v_alignbit_b32 v14, v6, v6, v239
    v_rcp_f32 v48, v48
    v_rcp_f32 v49, v49
    v_rcp_f32 v50, v50
    v_rcp_f32 v51, v51
    v_rcp_f32 v52, v52
    v_rcp_f32 v53, v53
    v_mfma_f32_32x32x16_bf16 v[32:47], v[80:83], v[144:147], 0
    v_and_b32 v13, v13, v240
    v_and_b32 v14, v14, v240
    v_rcp_f32 v54, v54
    v_rcp_f32 v55, v55
    v_mul_f32 v64, v64, v48
    v_mul_f32 v65, v65, v49
    v_mul_f32 v66, v66, v50
    s_add_u32 m0, s28, 0
    v_mul_f32 v67, v67, v51
    v_mfma_f32_32x32x16_bf16 v[16:31], v[84:87], v[120:123], v[16:31]
    s_waitcnt lgkmcnt(1)
    buffer_load_dwordx4 v8, s[4:7], 0 offen lds
    v_mul_f32 v68, v68, v52
    v_mul_f32 v69, v69, v53
    v_mul_f32 v70, v70, v54
    v_mul_f32 v71, v71, v55
    v_cvt_pk_bf16_f32 v48, v48, v49
    s_add_u32 m0, s28, 1024
    v_cvt_pk_bf16_f32 v49, v50, v51
    v_mfma_f32_32x32x16_bf16 v[32:47], v[84:87], v[152:155], v[32:47]
    buffer_load_dwordx4 v9, s[4:7], 0 offen lds
    v_cvt_pk_bf16_f32 v50, v52, v53
    v_cvt_pk_bf16_f32 v51, v54, v55
    v_cvt_pk_bf16_f32 v64, v64, v65
    v_cvt_pk_bf16_f32 v65, v66, v67
    v_cvt_pk_bf16_f32 v66, v68, v69
    s_add_u32 m0, s28, 2048
    v_cvt_pk_bf16_f32 v67, v70, v71
    v_mfma_f32_32x32x16_bf16 v[16:31], v[88:91], v[128:131], v[16:31]
    buffer_load_dwordx4 v10, s[4:7], 0 offen lds
    v_exp_f32 v56, v56
    v_exp_f32 v57, v57
    v_mfma_f32_16x16x32_bf16 v[196:199], v[104:107], v[48:51], v[196:199]
    v_mfma_f32_16x16x32_bf16 v[204:207], v[104:107], v[64:67], v[204:207]
    v_exp_f32 v58, v58
    ds_read_b128 v[104:107], v13 offset:0
    v_exp_f32 v59, v59
    v_exp_f32 v60, v60
    s_add_u32 m0, s28, 3072
    v_exp_f32 v61, v61
    v_mfma_f32_32x32x16_bf16 v[32:47], v[88:91], v[160:163], v[32:47]
    buffer_load_dwordx4 v11, s[4:7], 0 offen lds
    v_exp_f32 v62, v62
    v_exp_f32 v63, v63
    v_add_f32 v56, 1.0, v56
    v_add_f32 v57, 1.0, v57
    v_add_f32 v58, 1.0, v58
    s_add_u32 m0, s28, 4096
    v_add_f32 v59, 1.0, v59
    v_mfma_f32_32x32x16_bf16 v[16:31], v[92:95], v[136:139], v[16:31]
    buffer_load_dwordx4 v12, s[8:11], 0 offen lds
    s_waitcnt lgkmcnt(1)
    v_and_or_b32 v15, v5, s72, v241
    v_add_f32 v60, 1.0, v60
    v_add_f32 v61, 1.0, v61
    v_add_f32 v62, 1.0, v62
    v_add_f32 v63, 1.0, v63
    v_rcp_f32 v56, v56
    v_rcp_f32 v57, v57
    v_mfma_f32_32x32x16_bf16 v[32:47], v[92:95], v[168:171], v[32:47]
    v_rcp_f32 v58, v58
    v_rcp_f32 v59, v59
    v_rcp_f32 v60, v60
    v_rcp_f32 v61, v61
    v_rcp_f32 v62, v62
    v_rcp_f32 v63, v63
    v_mul_f32 v72, v72, v56
    v_mul_f32 v73, v73, v57
    v_mul_f32 v74, v74, v58
    v_mul_f32 v75, v75, v59
    v_mul_f32 v76, v76, v60
    v_mul_f32 v77, v77, v61
    v_mul_f32 v78, v78, v62
    v_mul_f32 v79, v79, v63
    v_cvt_pk_bf16_f32 v52, v56, v57
    v_cvt_pk_bf16_f32 v53, v58, v59
    v_cvt_pk_bf16_f32 v54, v60, v61
    v_cvt_pk_bf16_f32 v55, v62, v63
    v_cvt_pk_bf16_f32 v68, v72, v73
    v_cvt_pk_bf16_f32 v69, v74, v75
    v_cvt_pk_bf16_f32 v70, v76, v77
    v_cvt_pk_bf16_f32 v71, v78, v79
    s_sub_u32 s27, s27, 1
    s_cmp_eq_u32 s27, 0
    s_cbranch_scc1 K_FINAL
    v_add_u32 v234, 256, v234
    v_add_u32 v235, 256, v235
    v_add_u32 v236, 256, v236
    v_add_u32 v237, 64, v237
    s_branch K_LOOP
K_FINAL:
    s_waitcnt lgkmcnt(0)
    s_cmp_eq_u32 s101, 0
    s_cbranch_scc1 K_FINALH
    v_exp_f32 v16, v16
    v_exp_f32 v17, v17
    v_mfma_f32_16x16x32_bf16 v[196:199], v[108:111], v[52:55], v[196:199]
    v_mfma_f32_16x16x32_bf16 v[204:207], v[108:111], v[68:71], v[204:207]
    ds_read_b128 v[108:111], v14 offset:0
    v_exp_f32 v18, v18
    v_mfma_f32_32x32x16_bf16 v[48:63], v[100:103], v[188:191], 0
    v_exp_f32 v19, v19
    v_exp_f32 v20, v20
    v_exp_f32 v21, v21
    v_exp_f32 v22, v22
    v_exp_f32 v23, v23
    v_add_f32 v16, 1.0, v16
    v_mfma_f32_32x32x16_bf16 v[48:63], v[96:99], v[180:183], v[48:63]
    v_add_f32 v17, 1.0, v17
    v_add_f32 v18, 1.0, v18
    v_add_f32 v19, 1.0, v19
    v_add_f32 v20, 1.0, v20
    v_add_f32 v21, 1.0, v21
    v_add_f32 v22, 1.0, v22
    v_mfma_f32_32x32x16_bf16 v[48:63], v[80:83], v[116:119], v[48:63]
    v_add_f32 v23, 1.0, v23
    v_rcp_f32 v16, v16
    v_rcp_f32 v17, v17
    v_rcp_f32 v18, v18
    v_rcp_f32 v19, v19
    v_rcp_f32 v20, v20
    v_mfma_f32_32x32x16_bf16 v[64:79], v[80:83], v[148:151], 0
    v_rcp_f32 v21, v21
    v_rcp_f32 v22, v22
    v_rcp_f32 v23, v23
    v_mul_f32 v32, v32, v16
    v_mul_f32 v33, v33, v17
    v_mul_f32 v34, v34, v18
    v_mfma_f32_32x32x16_bf16 v[48:63], v[84:87], v[124:127], v[48:63]
    v_mul_f32 v35, v35, v19
    v_mul_f32 v36, v36, v20
    v_mul_f32 v37, v37, v21
    v_mul_f32 v38, v38, v22
    v_mul_f32 v39, v39, v23
    v_cvt_pk_bf16_f32 v16, v16, v17
    v_mfma_f32_32x32x16_bf16 v[64:79], v[84:87], v[156:159], v[64:79]
    v_cvt_pk_bf16_f32 v17, v18, v19
    v_cvt_pk_bf16_f32 v18, v20, v21
    v_cvt_pk_bf16_f32 v19, v22, v23
    v_cvt_pk_bf16_f32 v32, v32, v33
    v_cvt_pk_bf16_f32 v33, v34, v35
    v_cvt_pk_bf16_f32 v34, v36, v37
    v_mfma_f32_32x32x16_bf16 v[48:63], v[88:91], v[132:135], v[48:63]
    v_cvt_pk_bf16_f32 v35, v38, v39
    v_exp_f32 v24, v24
    v_exp_f32 v25, v25
    v_mfma_f32_16x16x32_bf16 v[192:195], v[104:107], v[16:19], v[192:195]
    v_mfma_f32_16x16x32_bf16 v[200:203], v[104:107], v[32:35], v[200:203]
    v_exp_f32 v26, v26
    v_exp_f32 v27, v27
    v_exp_f32 v28, v28
    v_mfma_f32_32x32x16_bf16 v[64:79], v[88:91], v[164:167], v[64:79]
    v_exp_f32 v29, v29
    v_exp_f32 v30, v30
    v_exp_f32 v31, v31
    v_add_f32 v24, 1.0, v24
    v_add_f32 v25, 1.0, v25
    v_add_f32 v26, 1.0, v26
    v_mfma_f32_32x32x16_bf16 v[48:63], v[92:95], v[140:143], v[48:63]
    v_add_f32 v27, 1.0, v27
    v_add_f32 v28, 1.0, v28
    v_add_f32 v29, 1.0, v29
    v_add_f32 v30, 1.0, v30
    v_add_f32 v31, 1.0, v31
    v_rcp_f32 v24, v24
    v_mfma_f32_32x32x16_bf16 v[64:79], v[92:95], v[172:175], v[64:79]
    v_rcp_f32 v25, v25
    v_rcp_f32 v26, v26
    v_rcp_f32 v27, v27
    v_rcp_f32 v28, v28
    v_rcp_f32 v29, v29
    v_rcp_f32 v30, v30
    v_rcp_f32 v31, v31
    v_mul_f32 v40, v40, v24
    v_mul_f32 v41, v41, v25
    v_mul_f32 v42, v42, v26
    v_mul_f32 v43, v43, v27
    v_mul_f32 v44, v44, v28
    v_mul_f32 v45, v45, v29
    v_mul_f32 v46, v46, v30
    v_mul_f32 v47, v47, v31
    v_cvt_pk_bf16_f32 v20, v24, v25
    v_cvt_pk_bf16_f32 v21, v26, v27
    v_cvt_pk_bf16_f32 v22, v28, v29
    v_cvt_pk_bf16_f32 v23, v30, v31
    v_cvt_pk_bf16_f32 v36, v40, v41
    v_cvt_pk_bf16_f32 v37, v42, v43
    v_cvt_pk_bf16_f32 v38, v44, v45
    v_cvt_pk_bf16_f32 v39, v46, v47
    v_exp_f32 v48, v48
    v_exp_f32 v49, v49
    s_waitcnt lgkmcnt(0)
    v_mfma_f32_16x16x32_bf16 v[192:195], v[108:111], v[20:23], v[192:195]
    v_mfma_f32_16x16x32_bf16 v[200:203], v[108:111], v[36:39], v[200:203]
    v_exp_f32 v50, v50
    v_exp_f32 v51, v51
    v_exp_f32 v52, v52
    v_exp_f32 v53, v53
    v_exp_f32 v54, v54
    v_exp_f32 v55, v55
    v_add_f32 v48, 1.0, v48
    v_add_f32 v49, 1.0, v49
    v_add_f32 v50, 1.0, v50
    v_add_f32 v51, 1.0, v51
    v_add_f32 v52, 1.0, v52
    v_add_f32 v53, 1.0, v53
    v_add_f32 v54, 1.0, v54
    v_add_f32 v55, 1.0, v55
    v_rcp_f32 v48, v48
    v_rcp_f32 v49, v49
    v_rcp_f32 v50, v50
    v_rcp_f32 v51, v51
    v_rcp_f32 v52, v52
    v_rcp_f32 v53, v53
    v_rcp_f32 v54, v54
    v_rcp_f32 v55, v55
    v_mul_f32 v64, v64, v48
    v_mul_f32 v65, v65, v49
    v_mul_f32 v66, v66, v50
    v_mul_f32 v67, v67, v51
    v_mul_f32 v68, v68, v52
    v_mul_f32 v69, v69, v53
    v_mul_f32 v70, v70, v54
    v_mul_f32 v71, v71, v55
    v_cvt_pk_bf16_f32 v48, v48, v49
    v_cvt_pk_bf16_f32 v49, v50, v51
    v_cvt_pk_bf16_f32 v50, v52, v53
    v_cvt_pk_bf16_f32 v51, v54, v55
    v_cvt_pk_bf16_f32 v64, v64, v65
    v_cvt_pk_bf16_f32 v65, v66, v67
    v_cvt_pk_bf16_f32 v66, v68, v69
    v_cvt_pk_bf16_f32 v67, v70, v71
    v_exp_f32 v56, v56
    v_exp_f32 v57, v57
    v_mfma_f32_16x16x32_bf16 v[196:199], v[104:107], v[48:51], v[196:199]
    v_mfma_f32_16x16x32_bf16 v[204:207], v[104:107], v[64:67], v[204:207]
    v_exp_f32 v58, v58
    v_exp_f32 v59, v59
    v_exp_f32 v60, v60
    v_exp_f32 v61, v61
    v_exp_f32 v62, v62
    v_exp_f32 v63, v63
    v_add_f32 v56, 1.0, v56
    v_add_f32 v57, 1.0, v57
    v_add_f32 v58, 1.0, v58
    v_add_f32 v59, 1.0, v59
    v_add_f32 v60, 1.0, v60
    v_add_f32 v61, 1.0, v61
    v_add_f32 v62, 1.0, v62
    v_add_f32 v63, 1.0, v63
    v_rcp_f32 v56, v56
    v_rcp_f32 v57, v57
    v_rcp_f32 v58, v58
    v_rcp_f32 v59, v59
    v_rcp_f32 v60, v60
    v_rcp_f32 v61, v61
    v_rcp_f32 v62, v62
    v_rcp_f32 v63, v63
    v_mul_f32 v72, v72, v56
    v_mul_f32 v73, v73, v57
    v_mul_f32 v74, v74, v58
    v_mul_f32 v75, v75, v59
    v_mul_f32 v76, v76, v60
    v_mul_f32 v77, v77, v61
    v_mul_f32 v78, v78, v62
    v_mul_f32 v79, v79, v63
    v_cvt_pk_bf16_f32 v52, v56, v57
    v_cvt_pk_bf16_f32 v53, v58, v59
    v_cvt_pk_bf16_f32 v54, v60, v61
    v_cvt_pk_bf16_f32 v55, v62, v63
    v_cvt_pk_bf16_f32 v68, v72, v73
    v_cvt_pk_bf16_f32 v69, v74, v75
    v_cvt_pk_bf16_f32 v70, v76, v77
    v_cvt_pk_bf16_f32 v71, v78, v79
    s_nop 1
    v_mfma_f32_16x16x32_bf16 v[196:199], v[108:111], v[52:55], v[196:199]
    v_mfma_f32_16x16x32_bf16 v[204:207], v[108:111], v[68:71], v[204:207]
    s_branch K_LOOPEND
K_FINALH:
    v_exp_f32 v16, v16
    v_exp_f32 v17, v17
    v_mfma_f32_16x16x32_bf16 v[196:199], v[108:111], v[52:55], v[196:199]
    v_mfma_f32_16x16x32_bf16 v[204:207], v[108:111], v[68:71], v[204:207]
    v_exp_f32 v18, v18
    v_mfma_f32_32x32x16_bf16 v[48:63], v[100:103], v[188:191], 0
    v_exp_f32 v19, v19
    v_exp_f32 v20, v20
    v_exp_f32 v21, v21
    v_mfma_f32_32x32x16_bf16 v[48:63], v[96:99], v[180:183], v[48:63]
    v_exp_f32 v22, v22
    v_exp_f32 v23, v23
    v_add_f32 v16, 1.0, v16
    v_mfma_f32_32x32x16_bf16 v[48:63], v[80:83], v[116:119], v[48:63]
    v_add_f32 v17, 1.0, v17
    v_add_f32 v18, 1.0, v18
    v_add_f32 v19, 1.0, v19
    v_mfma_f32_32x32x16_bf16 v[48:63], v[84:87], v[124:127], v[48:63]
    v_add_f32 v20, 1.0, v20
    v_add_f32 v21, 1.0, v21
    v_add_f32 v22, 1.0, v22
    v_mfma_f32_32x32x16_bf16 v[48:63], v[88:91], v[132:135], v[48:63]
    v_add_f32 v23, 1.0, v23
    v_rcp_f32 v16, v16
    v_rcp_f32 v17, v17
    v_mfma_f32_32x32x16_bf16 v[48:63], v[92:95], v[140:143], v[48:63]
    v_rcp_f32 v18, v18
    v_rcp_f32 v19, v19
    v_rcp_f32 v20, v20
    v_mfma_f32_32x32x16_bf16 v[64:79], v[80:83], v[148:151], 0
    v_rcp_f32 v21, v21
    v_rcp_f32 v22, v22
    v_rcp_f32 v23, v23
    v_mfma_f32_32x32x16_bf16 v[64:79], v[84:87], v[156:159], v[64:79]
    v_mul_f32 v32, v32, v16
    v_mul_f32 v33, v33, v17
    v_mul_f32 v34, v34, v18
    v_mfma_f32_32x32x16_bf16 v[64:79], v[88:91], v[164:167], v[64:79]
    v_mul_f32 v35, v35, v19
    v_mul_f32 v36, v36, v20
    v_mul_f32 v37, v37, v21
    v_mfma_f32_32x32x16_bf16 v[64:79], v[92:95], v[172:175], v[64:79]
    v_mul_f32 v38, v38, v22
    v_mul_f32 v39, v39, v23
    v_cvt_pk_bf16_f32 v16, v16, v17
    v_cvt_pk_bf16_f32 v17, v18, v19
    v_cvt_pk_bf16_f32 v18, v20, v21
    v_cvt_pk_bf16_f32 v19, v22, v23
    v_cvt_pk_bf16_f32 v32, v32, v33
    v_cvt_pk_bf16_f32 v33, v34, v35
    v_cvt_pk_bf16_f32 v34, v36, v37
    v_cvt_pk_bf16_f32 v35, v38, v39
    v_exp_f32 v48, v48
    v_exp_f32 v49, v49
    v_mfma_f32_16x16x32_bf16 v[192:195], v[104:107], v[16:19], v[192:195]
    v_mfma_f32_16x16x32_bf16 v[200:203], v[104:107], v[32:35], v[200:203]
    v_exp_f32 v50, v50
    v_exp_f32 v51, v51
    v_exp_f32 v52, v52
    v_exp_f32 v53, v53
    v_exp_f32 v54, v54
    v_exp_f32 v55, v55
    v_add_f32 v48, 1.0, v48
    v_add_f32 v49, 1.0, v49
    v_add_f32 v50, 1.0, v50
    v_add_f32 v51, 1.0, v51
    v_add_f32 v52, 1.0, v52
    v_add_f32 v53, 1.0, v53
    v_add_f32 v54, 1.0, v54
    v_add_f32 v55, 1.0, v55
    v_rcp_f32 v48, v48
    v_rcp_f32 v49, v49
    v_rcp_f32 v50, v50
    v_rcp_f32 v51, v51
    v_rcp_f32 v52, v52
    v_rcp_f32 v53, v53
    v_rcp_f32 v54, v54
    v_rcp_f32 v55, v55
    v_mul_f32 v64, v64, v48
    v_mul_f32 v65, v65, v49
    v_mul_f32 v66, v66, v50
    v_mul_f32 v67, v67, v51
    v_mul_f32 v68, v68, v52
    v_mul_f32 v69, v69, v53
    v_mul_f32 v70, v70, v54
    v_mul_f32 v71, v71, v55
    v_cvt_pk_bf16_f32 v48, v48, v49
    v_cvt_pk_bf16_f32 v49, v50, v51
    v_cvt_pk_bf16_f32 v50, v52, v53
    v_cvt_pk_bf16_f32 v51, v54, v55
    v_cvt_pk_bf16_f32 v64, v64, v65
    v_cvt_pk_bf16_f32 v65, v66, v67
    v_cvt_pk_bf16_f32 v66, v68, v69
    v_cvt_pk_bf16_f32 v67, v70, v71
    s_nop 1
    v_mfma_f32_16x16x32_bf16 v[196:199], v[104:107], v[48:51], v[196:199]
    v_mfma_f32_16x16x32_bf16 v[204:207], v[104:107], v[64:67], v[204:207]
K_LOOPEND:
    s_waitcnt vmcnt(0) lgkmcnt(0)
    s_setprio 0
    s_cmp_eq_u32 s64, 1
    s_cbranch_scc1 K_NEXT
K_EPI:
    s_nop 7
    s_mov_b32 s29, 0x358637bd
    s_sub_u32 s30, s28, s3
    v_add_u32 v2, s30, v242
    v_add_f32 v192, s29, v192
    v_add_f32 v193, s29, v193
    v_add_f32 v194, s29, v194
    v_add_f32 v195, s29, v195
    v_rcp_f32 v192, v192
    v_rcp_f32 v193, v193
    v_rcp_f32 v194, v194
    v_rcp_f32 v195, v195
    s_nop 0
    v_fma_f32 v200, v200, v192, v208
    v_fma_f32 v201, v201, v193, v209
    v_fma_f32 v202, v202, v194, v210
    v_fma_f32 v203, v203, v195, v211
    v_max_f32 v200, 0, v200
    v_max_f32 v201, 0, v201
    v_max_f32 v202, 0, v202
    v_max_f32 v203, 0, v203
    v_lshlrev_b32 v216, 16, v216
    v_lshlrev_b32 v217, 16, v217
    v_lshlrev_b32 v218, 16, v218
    v_lshlrev_b32 v219, 16, v219
    v_add_f32 v200, v200, v216
    v_add_f32 v201, v201, v217
    v_add_f32 v202, v202, v218
    v_add_f32 v203, v203, v219
    v_cvt_pk_bf16_f32 v200, v200, v200
    v_cvt_pk_bf16_f32 v201, v201, v201
    v_cvt_pk_bf16_f32 v202, v202, v202
    v_cvt_pk_bf16_f32 v203, v203, v203
    ds_write_b16 v2, v200 offset:0
    ds_write_b16 v2, v201 offset:128
    ds_write_b16 v2, v202 offset:256
    ds_write_b16 v2, v203 offset:384
    v_add_f32 v196, s29, v196
    v_add_f32 v197, s29, v197
    v_add_f32 v198, s29, v198
    v_add_f32 v199, s29, v199
    v_rcp_f32 v196, v196
    v_rcp_f32 v197, v197
    v_rcp_f32 v198, v198
    v_rcp_f32 v199, v199
    s_nop 0
    v_fma_f32 v204, v204, v196, v212
    v_fma_f32 v205, v205, v197, v213
    v_fma_f32 v206, v206, v198, v214
    v_fma_f32 v207, v207, v199, v215
    v_max_f32 v204, 0, v204
    v_max_f32 v205, 0, v205
    v_max_f32 v206, 0, v206
    v_max_f32 v207, 0, v207
    v_lshlrev_b32 v220, 16, v220
    v_lshlrev_b32 v221, 16, v221
    v_lshlrev_b32 v222, 16, v222
    v_lshlrev_b32 v223, 16, v223
    v_add_f32 v204, v204, v220
    v_add_f32 v205, v205, v221
    v_add_f32 v206, v206, v222
    v_add_f32 v207, v207, v223
    v_cvt_pk_bf16_f32 v204, v204, v204
    v_cvt_pk_bf16_f32 v205, v205, v205
    v_cvt_pk_bf16_f32 v206, v206, v206
    v_cvt_pk_bf16_f32 v207, v207, v207
    ds_write_b16 v2, v204 offset:64
    ds_write_b16 v2, v205 offset:192
    ds_write_b16 v2, v206 offset:320
    ds_write_b16 v2, v207 offset:448
    v_add_u32 v3, s28, v248
    s_waitcnt lgkmcnt(0)
    ds_read_b128 v[4:7], v3
    v_add_u32 v3, s3, v248
    s_mov_b32 exec_hi, 0xff
    s_waitcnt lgkmcnt(0)
    buffer_store_dwordx4 v[4:7], v3, s[20:23], 0 offen sc1
    s_mov_b64 exec, -1
    s_endpgm
K_OVER:
    s_mov_b32 s64, 1
    s_mov_b32 s65, 0
    s_mov_b32 s66, 0
    s_mov_b32 s100, 0
    s_waitcnt vmcnt(0)
    s_branch K_ROUND
K_NEXT:
    s_lshl_b32 s29, s65, 10
    s_lshl_b32 s30, s25, 2
    s_add_u32 s29, s29, s30
    v_mov_b32 v4, s29
    buffer_load_dword v5, v4, s[16:19], 0 offen sc1
    s_waitcnt vmcnt(0)
    v_lshrrev_b32 v6, 16, v5
    v_and_b32 v5, 0xffff, v5
    v_sub_u32 v5, v6, v5
    s_nop 0
    v_readfirstlane_b32 s29, v5
    s_nop 3
    s_min_u32 s29, s29, 2560
    s_add_u32 s66, s66, 416
    s_cmp_lt_u32 s66, s29
    s_cbranch_scc1 K_ROUND
    s_mov_b32 s66, 0
    s_add_u32 s65, s65, 1
    s_cmp_ge_u32 s65, 250
    s_cbranch_scc1 K_EPI
K_ROUND:
    s_waitcnt lgkmcnt(0)
    s_nop 7
    s_barrier
    v_mov_b32 v4, 0
    v_mov_b32 v5, 0
    v_mov_b32 v6, 0
    v_mov_b32 v7, 0
    v_lshlrev_b32 v12, 4, v250
    v_cmp_gt_u32 vcc, 272, v250
    s_and_saveexec_b64 s[74:75], vcc
    ds_write_b128 v12, v[4:7] offset:4352
    s_mov_b64 exec, s[74:75]
    v_mov_b32 v234, v244
    v_mov_b32 v235, v245
    v_mov_b32 v236, v246
    v_mov_b32 v237, v247
    v_lshrrev_b32 v3, 7, v248
    s_lshl_b32 s29, s24, 3
    v_add_u32 v3, s29, v3
    s_lshl_b32 s30, s25, 2
    v_lshl_add_u32 v1, v3, 10, s30
    v_mul_u32_u24 v0, 10240, v3
    v_lshlrev_b32 v7, 3, v0
    v_bfe_u32 v2, v248, 4, 3
    v_lshlrev_b32 v2, 1, v2
    buffer_load_dword v96, v1, s[16:19], 0 offen sc1
    v_add_u32 v105, 65536, v1
    buffer_load_dword v97, v105, s[16:19], 0 offen sc1
    v_add_u32 v106, 131072, v1
    buffer_load_dword v98, v106, s[16:19], 0 offen sc1
    v_add_u32 v107, 196608, v1
    buffer_load_dword v99, v107, s[16:19], 0 offen sc1
    s_waitcnt vmcnt(0) lgkmcnt(0)
    s_barrier
    v_lshrrev_b32 v6, 10, v1
    v_and_b32 v3, 0xffff, v96
    v_lshrrev_b32 v4, 16, v96
    v_add_u32 v3, s66, v3
    v_add_u32 v5, 416, v3
    v_min_u32 v4, v4, v5
    v_min_u32 v3, v3, v4
    v_lshl_or_b32 v3, v4, 16, v3
    v_add_u32 v5, 0, v6
    v_cmp_eq_u32 vcc, s65, v5
    s_nop 1
    v_cndmask_b32 v96, 0, v3, vcc
    v_and_b32 v3, 0xffff, v97
    v_lshrrev_b32 v4, 16, v97
    v_add_u32 v3, s66, v3
    v_add_u32 v5, 416, v3
    v_min_u32 v4, v4, v5
    v_min_u32 v3, v3, v4
    v_lshl_or_b32 v3, v4, 16, v3
    v_add_u32 v5, 64, v6
    v_cmp_eq_u32 vcc, s65, v5
    s_nop 1
    v_cndmask_b32 v97, 0, v3, vcc
    v_and_b32 v3, 0xffff, v98
    v_lshrrev_b32 v4, 16, v98
    v_add_u32 v3, s66, v3
    v_add_u32 v5, 416, v3
    v_min_u32 v4, v4, v5
    v_min_u32 v3, v3, v4
    v_lshl_or_b32 v3, v4, 16, v3
    v_add_u32 v5, 128, v6
    v_cmp_eq_u32 vcc, s65, v5
    s_nop 1
    v_cndmask_b32 v98, 0, v3, vcc
    v_and_b32 v3, 0xffff, v99
    v_lshrrev_b32 v4, 16, v99
    v_add_u32 v3, s66, v3
    v_add_u32 v5, 416, v3
    v_min_u32 v4, v4, v5
    v_min_u32 v3, v3, v4
    v_lshl_or_b32 v3, v4, 16, v3
    v_add_u32 v5, 192, v6
    v_cmp_eq_u32 vcc, s65, v5
    s_nop 1
    v_cndmask_b32 v99, 0, v3, vcc
    v_mov_b32 v6, 0
    v_and_b32 v3, 0xffff, v96
    v_lshrrev_b32 v4, 16, v96
    v_add_u32 v3, v3, v2
    s_mov_b32 s67, 0
    v_sub_u32 v4, v4, v3
    v_lshl_add_u32 v104, v3, 2, v0
    v_cmp_lt_i32 s[48:49], 16, v4
    buffer_load_dwordx2 v[16:17], v104, s[12:15], s67 offen sc1
    v_cmp_lt_i32 s[32:33], 0, v4
    v_cmp_lt_i32 s[34:35], 1, v4
    v_max_i32 v6, v6, v4
    s_cmp_eq_u64 s[48:49], 0
    s_cbranch_scc1 KS_NB0
    v_cmp_lt_i32 s[50:51], 17, v4
    s_mov_b64 exec, s[48:49]
    buffer_load_dwordx2 v[24:25], v104, s[12:15], s67 offen offset:64 sc1
    s_mov_b64 exec, -1
KS_NB0:
    v_and_b32 v3, 0xffff, v97
    v_lshrrev_b32 v4, 16, v97
    v_add_u32 v3, v3, v2
    s_mov_b32 s67, 655360
    v_sub_u32 v4, v4, v3
    v_lshl_add_u32 v105, v3, 2, v0
    v_cmp_lt_i32 s[52:53], 16, v4
    buffer_load_dwordx2 v[18:19], v105, s[12:15], s67 offen sc1
    v_cmp_lt_i32 s[36:37], 0, v4
    v_cmp_lt_i32 s[38:39], 1, v4
    v_max_i32 v6, v6, v4
    s_cmp_eq_u64 s[52:53], 0
    s_cbranch_scc1 KS_NB1
    v_cmp_lt_i32 s[54:55], 17, v4
    s_mov_b64 exec, s[52:53]
    buffer_load_dwordx2 v[26:27], v105, s[12:15], s67 offen offset:64 sc1
    s_mov_b64 exec, -1
KS_NB1:
    v_and_b32 v3, 0xffff, v98
    v_lshrrev_b32 v4, 16, v98
    v_add_u32 v3, v3, v2
    s_mov_b32 s67, 1310720
    v_sub_u32 v4, v4, v3
    v_lshl_add_u32 v106, v3, 2, v0
    v_cmp_lt_i32 s[56:57], 16, v4
    buffer_load_dwordx2 v[20:21], v106, s[12:15], s67 offen sc1
    v_cmp_lt_i32 s[40:41], 0, v4
    v_cmp_lt_i32 s[42:43], 1, v4
    v_max_i32 v6, v6, v4
    s_cmp_eq_u64 s[56:57], 0
    s_cbranch_scc1 KS_NB2
    v_cmp_lt_i32 s[58:59], 17, v4
    s_mov_b64 exec, s[56:57]
    buffer_load_dwordx2 v[28:29], v106, s[12:15], s67 offen offset:64 sc1
    s_mov_b64 exec, -1
KS_NB2:
    v_and_b32 v3, 0xffff, v99
    v_lshrrev_b32 v4, 16, v99
    v_add_u32 v3, v3, v2
    s_mov_b32 s67, 1966080
    v_sub_u32 v4, v4, v3
    v_lshl_add_u32 v107, v3, 2, v0
    v_cmp_lt_i32 s[60:61], 16, v4
    buffer_load_dwordx2 v[22:23], v107, s[12:15], s67 offen sc1
    v_cmp_lt_i32 s[44:45], 0, v4
    v_cmp_lt_i32 s[46:47], 1, v4
    v_max_i32 v6, v6, v4
    s_cmp_eq_u64 s[60:61], 0
    s_cbranch_scc1 KS_NB3
    v_cmp_lt_i32 s[62:63], 17, v4
    s_mov_b64 exec, s[60:61]
    buffer_load_dwordx2 v[30:31], v107, s[12:15], s67 offen offset:64 sc1
    s_mov_b64 exec, -1
KS_NB3:
    v_cmp_lt_i32 vcc, 32, v6
    s_nop 0
    s_or_b32 s73, vcc_lo, vcc_hi
    s_waitcnt vmcnt(0)
    s_mov_b64 exec, s[32:33]
    v_lshrrev_b32 v3, 15, v16
    v_and_b32 v8, 0x1c, v3
    ds_add_rtn_u32 v104, v8, v249 offset:4352
    s_mov_b64 exec, s[34:35]
    v_lshrrev_b32 v3, 15, v17
    v_and_b32 v9, 0x1c, v3
    ds_add_rtn_u32 v105, v9, v249 offset:4352
    s_mov_b64 exec, s[36:37]
    v_lshrrev_b32 v3, 15, v18
    v_and_b32 v10, 0x1c, v3
    ds_add_rtn_u32 v106, v10, v249 offset:4352
    s_mov_b64 exec, s[38:39]
    v_lshrrev_b32 v3, 15, v19
    v_and_b32 v11, 0x1c, v3
    ds_add_rtn_u32 v107, v11, v249 offset:4352
    s_mov_b64 exec, s[40:41]
    v_lshrrev_b32 v3, 15, v20
    v_and_b32 v12, 0x1c, v3
    ds_add_rtn_u32 v108, v12, v249 offset:4352
    s_mov_b64 exec, s[42:43]
    v_lshrrev_b32 v3, 15, v21
    v_and_b32 v13, 0x1c, v3
    ds_add_rtn_u32 v109, v13, v249 offset:4352
    s_mov_b64 exec, s[44:45]
    v_lshrrev_b32 v3, 15, v22
    v_and_b32 v14, 0x1c, v3
    ds_add_rtn_u32 v110, v14, v249 offset:4352
    s_mov_b64 exec, s[46:47]
    v_lshrrev_b32 v3, 15, v23
    v_and_b32 v15, 0x1c, v3
    ds_add_rtn_u32 v111, v15, v249 offset:4352
    s_waitcnt lgkmcnt(7)
    s_mov_b64 exec, s[32:33]
    s_mov_b32 s67, 0
    v_min_u32 v104, 0x1ff, v104
    v_lshrrev_b32 v3, 15, v16
    v_lshlrev_b32 v4, 9, v8
    v_and_b32 v3, 0x1ffe0, v3
    v_lshl_add_u32 v4, v104, 2, v4
    v_add3_u32 v3, v3, v7, s67
    v_lshlrev_b32 v5, 4, v16
    v_and_b32 v5, 0x1ffff0, v5
    ds_write2st64_b32 v4, v5, v3 offset0:34 offset1:98
    v_lshrrev_b32 v4, 2, v4
    v_lshlrev_b32 v5, 2, v16
    v_and_b32 v5, 0x1c, v5
    v_and_or_b32 v4, v4, s71, v5
    v_lshlrev_b32 v3, v104, v249
    ds_or_b32 v4, v3 offset:4608
    s_waitcnt lgkmcnt(8)
    s_mov_b64 exec, s[34:35]
    s_mov_b32 s67, 0
    v_min_u32 v105, 0x1ff, v105
    v_lshrrev_b32 v3, 15, v17
    v_lshlrev_b32 v4, 9, v9
    v_and_b32 v3, 0x1ffe0, v3
    v_lshl_add_u32 v4, v105, 2, v4
    v_add3_u32 v3, v3, v7, s67
    v_lshlrev_b32 v5, 4, v17
    v_and_b32 v5, 0x1ffff0, v5
    ds_write2st64_b32 v4, v5, v3 offset0:34 offset1:98
    v_lshrrev_b32 v4, 2, v4
    v_lshlrev_b32 v5, 2, v17
    v_and_b32 v5, 0x1c, v5
    v_and_or_b32 v4, v4, s71, v5
    v_lshlrev_b32 v3, v105, v249
    ds_or_b32 v4, v3 offset:4608
    s_waitcnt lgkmcnt(9)
    s_mov_b64 exec, s[36:37]
    s_mov_b32 s67, 5242880
    v_min_u32 v106, 0x1ff, v106
    v_lshrrev_b32 v3, 15, v18
    v_lshlrev_b32 v4, 9, v10
    v_and_b32 v3, 0x1ffe0, v3
    v_lshl_add_u32 v4, v106, 2, v4
    v_add3_u32 v3, v3, v7, s67
    v_lshlrev_b32 v5, 4, v18
    v_and_b32 v5, 0x1ffff0, v5
    ds_write2st64_b32 v4, v5, v3 offset0:34 offset1:98
    v_lshrrev_b32 v4, 2, v4
    v_lshlrev_b32 v5, 2, v18
    v_and_b32 v5, 0x1c, v5
    v_and_or_b32 v4, v4, s71, v5
    v_lshlrev_b32 v3, v106, v249
    ds_or_b32 v4, v3 offset:4608
    s_waitcnt lgkmcnt(10)
    s_mov_b64 exec, s[38:39]
    s_mov_b32 s67, 5242880
    v_min_u32 v107, 0x1ff, v107
    v_lshrrev_b32 v3, 15, v19
    v_lshlrev_b32 v4, 9, v11
    v_and_b32 v3, 0x1ffe0, v3
    v_lshl_add_u32 v4, v107, 2, v4
    v_add3_u32 v3, v3, v7, s67
    v_lshlrev_b32 v5, 4, v19
    v_and_b32 v5, 0x1ffff0, v5
    ds_write2st64_b32 v4, v5, v3 offset0:34 offset1:98
    v_lshrrev_b32 v4, 2, v4
    v_lshlrev_b32 v5, 2, v19
    v_and_b32 v5, 0x1c, v5
    v_and_or_b32 v4, v4, s71, v5
    v_lshlrev_b32 v3, v107, v249
    ds_or_b32 v4, v3 offset:4608
    s_waitcnt lgkmcnt(9)
    s_mov_b64 exec, s[40:41]
    s_mov_b32 s67, 10485760
    v_min_u32 v108, 0x1ff, v108
    v_lshrrev_b32 v3, 15, v20
    v_lshlrev_b32 v4, 9, v12
    v_and_b32 v3, 0x1ffe0, v3
    v_lshl_add_u32 v4, v108, 2, v4
    v_add3_u32 v3, v3, v7, s67
    v_lshlrev_b32 v5, 4, v20
    v_and_b32 v5, 0x1ffff0, v5
    ds_write2st64_b32 v4, v5, v3 offset0:34 offset1:98
    v_lshrrev_b32 v4, 2, v4
    v_lshlrev_b32 v5, 2, v20
    v_and_b32 v5, 0x1c, v5
    v_and_or_b32 v4, v4, s71, v5
    v_lshlrev_b32 v3, v108, v249
    ds_or_b32 v4, v3 offset:4608
    s_waitcnt lgkmcnt(8)
    s_mov_b64 exec, s[42:43]
    s_mov_b32 s67, 10485760
    v_min_u32 v109, 0x1ff, v109
    v_lshrrev_b32 v3, 15, v21
    v_lshlrev_b32 v4, 9, v13
    v_and_b32 v3, 0x1ffe0, v3
    v_lshl_add_u32 v4, v109, 2, v4
    v_add3_u32 v3, v3, v7, s67
    v_lshlrev_b32 v5, 4, v21
    v_and_b32 v5, 0x1ffff0, v5
    ds_write2st64_b32 v4, v5, v3 offset0:34 offset1:98
    v_lshrrev_b32 v4, 2, v4
    v_lshlrev_b32 v5, 2, v21
    v_and_b32 v5, 0x1c, v5
    v_and_or_b32 v4, v4, s71, v5
    v_lshlrev_b32 v3, v109, v249
    ds_or_b32 v4, v3 offset:4608
    s_waitcnt lgkmcnt(7)
    s_mov_b64 exec, s[44:45]
    s_mov_b32 s67, 15728640
    v_min_u32 v110, 0x1ff, v110
    v_lshrrev_b32 v3, 15, v22
    v_lshlrev_b32 v4, 9, v14
    v_and_b32 v3, 0x1ffe0, v3
    v_lshl_add_u32 v4, v110, 2, v4
    v_add3_u32 v3, v3, v7, s67
    v_lshlrev_b32 v5, 4, v22
    v_and_b32 v5, 0x1ffff0, v5
    ds_write2st64_b32 v4, v5, v3 offset0:34 offset1:98
    v_lshrrev_b32 v4, 2, v4
    v_lshlrev_b32 v5, 2, v22
    v_and_b32 v5, 0x1c, v5
    v_and_or_b32 v4, v4, s71, v5
    v_lshlrev_b32 v3, v110, v249
    ds_or_b32 v4, v3 offset:4608
    s_waitcnt lgkmcnt(6)
    s_mov_b64 exec, s[46:47]
    s_mov_b32 s67, 15728640
    v_min_u32 v111, 0x1ff, v111
    v_lshrrev_b32 v3, 15, v23
    v_lshlrev_b32 v4, 9, v15
    v_and_b32 v3, 0x1ffe0, v3
    v_lshl_add_u32 v4, v111, 2, v4
    v_add3_u32 v3, v3, v7, s67
    v_lshlrev_b32 v5, 4, v23
    v_and_b32 v5, 0x1ffff0, v5
    ds_write2st64_b32 v4, v5, v3 offset0:34 offset1:98
    v_lshrrev_b32 v4, 2, v4
    v_lshlrev_b32 v5, 2, v23
    v_and_b32 v5, 0x1c, v5
    v_and_or_b32 v4, v4, s71, v5
    v_lshlrev_b32 v3, v111, v249
    ds_or_b32 v4, v3 offset:4608
    s_mov_b64 exec, -1
    s_cmp_lg_u64 s[48:49], 0
    s_cbranch_scc1 KS_HB0
KS_RB0:
    s_cmp_lg_u64 s[52:53], 0
    s_cbranch_scc1 KS_HB1
KS_RB1:
    s_cmp_lg_u64 s[56:57], 0
    s_cbranch_scc1 KS_HB2
KS_RB2:
    s_cmp_lg_u64 s[60:61], 0
    s_cbranch_scc1 KS_HB3
KS_RB3:
    s_cmp_lg_u32 s73, 0
    s_cbranch_scc1 KS_MORE
KS_DONE:
    s_waitcnt lgkmcnt(0)
    s_barrier
    s_branch K_SETUP
KF_HB0:
    s_waitcnt lgkmcnt(8)
    s_mov_b32 s67, 0
    s_mov_b64 exec, s[48:49]
    v_lshrrev_b32 v3, 15, v24
    v_and_b32 v8, 0x1c, v3
    ds_add_rtn_u32 v104, v8, v249 offset:4352
    s_mov_b64 exec, s[50:51]
    v_lshrrev_b32 v3, 15, v25
    v_and_b32 v9, 0x1c, v3
    ds_add_rtn_u32 v105, v9, v249 offset:4352
    s_waitcnt lgkmcnt(0)
    s_mov_b64 exec, s[48:49]
    v_min_u32 v104, 0x1ff, v104
    v_lshrrev_b32 v3, 15, v24
    v_lshlrev_b32 v4, 9, v8
    v_and_b32 v3, 0x1ffe0, v3
    v_lshl_add_u32 v4, v104, 2, v4
    v_add3_u32 v3, v3, v7, s67
    v_lshlrev_b32 v5, 4, v24
    v_and_b32 v5, 0x1ffff0, v5
    ds_write2st64_b32 v4, v5, v3 offset0:34 offset1:98
    v_lshrrev_b32 v4, 2, v4
    v_lshlrev_b32 v5, 2, v24
    v_and_b32 v5, 0x1c, v5
    v_and_or_b32 v4, v4, s71, v5
    v_lshlrev_b32 v3, v104, v249
    ds_or_b32 v4, v3 offset:4608
    s_mov_b64 exec, s[50:51]
    v_min_u32 v105, 0x1ff, v105
    v_lshrrev_b32 v3, 15, v25
    v_lshlrev_b32 v4, 9, v9
    v_and_b32 v3, 0x1ffe0, v3
    v_lshl_add_u32 v4, v105, 2, v4
    v_add3_u32 v3, v3, v7, s67
    v_lshlrev_b32 v5, 4, v25
    v_and_b32 v5, 0x1ffff0, v5
    ds_write2st64_b32 v4, v5, v3 offset0:34 offset1:98
    v_lshrrev_b32 v4, 2, v4
    v_lshlrev_b32 v5, 2, v25
    v_and_b32 v5, 0x1c, v5
    v_and_or_b32 v4, v4, s71, v5
    v_lshlrev_b32 v3, v105, v249
    ds_or_b32 v4, v3 offset:4608
    s_mov_b64 exec, -1
    s_waitcnt lgkmcnt(0)
    s_branch KF_RB0
KF_HB1:
    s_waitcnt lgkmcnt(8)
    s_mov_b32 s67, 5242880
    s_mov_b64 exec, s[52:53]
    v_lshrrev_b32 v3, 15, v26
    v_and_b32 v10, 0x1c, v3
    ds_add_rtn_u32 v106, v10, v249 offset:4352
    s_mov_b64 exec, s[54:55]
    v_lshrrev_b32 v3, 15, v27
    v_and_b32 v11, 0x1c, v3
    ds_add_rtn_u32 v107, v11, v249 offset:4352
    s_waitcnt lgkmcnt(0)
    s_mov_b64 exec, s[52:53]
    v_min_u32 v106, 0x1ff, v106
    v_lshrrev_b32 v3, 15, v26
    v_lshlrev_b32 v4, 9, v10
    v_and_b32 v3, 0x1ffe0, v3
    v_lshl_add_u32 v4, v106, 2, v4
    v_add3_u32 v3, v3, v7, s67
    v_lshlrev_b32 v5, 4, v26
    v_and_b32 v5, 0x1ffff0, v5
    ds_write2st64_b32 v4, v5, v3 offset0:34 offset1:98
    v_lshrrev_b32 v4, 2, v4
    v_lshlrev_b32 v5, 2, v26
    v_and_b32 v5, 0x1c, v5
    v_and_or_b32 v4, v4, s71, v5
    v_lshlrev_b32 v3, v106, v249
    ds_or_b32 v4, v3 offset:4608
    s_mov_b64 exec, s[54:55]
    v_min_u32 v107, 0x1ff, v107
    v_lshrrev_b32 v3, 15, v27
    v_lshlrev_b32 v4, 9, v11
    v_and_b32 v3, 0x1ffe0, v3
    v_lshl_add_u32 v4, v107, 2, v4
    v_add3_u32 v3, v3, v7, s67
    v_lshlrev_b32 v5, 4, v27
    v_and_b32 v5, 0x1ffff0, v5
    ds_write2st64_b32 v4, v5, v3 offset0:34 offset1:98
    v_lshrrev_b32 v4, 2, v4
    v_lshlrev_b32 v5, 2, v27
    v_and_b32 v5, 0x1c, v5
    v_and_or_b32 v4, v4, s71, v5
    v_lshlrev_b32 v3, v107, v249
    ds_or_b32 v4, v3 offset:4608
    s_mov_b64 exec, -1
    s_waitcnt lgkmcnt(0)
    s_branch KF_RB1
KF_HB2:
    s_waitcnt lgkmcnt(8)
    s_mov_b32 s67, 10485760
    s_mov_b64 exec, s[56:57]
    v_lshrrev_b32 v3, 15, v28
    v_and_b32 v12, 0x1c, v3
    ds_add_rtn_u32 v108, v12, v249 offset:4352
    s_mov_b64 exec, s[58:59]
    v_lshrrev_b32 v3, 15, v29
    v_and_b32 v13, 0x1c, v3
    ds_add_rtn_u32 v109, v13, v249 offset:4352
    s_waitcnt lgkmcnt(0)
    s_mov_b64 exec, s[56:57]
    v_min_u32 v108, 0x1ff, v108
    v_lshrrev_b32 v3, 15, v28
    v_lshlrev_b32 v4, 9, v12
    v_and_b32 v3, 0x1ffe0, v3
    v_lshl_add_u32 v4, v108, 2, v4
    v_add3_u32 v3, v3, v7, s67
    v_lshlrev_b32 v5, 4, v28
    v_and_b32 v5, 0x1ffff0, v5
    ds_write2st64_b32 v4, v5, v3 offset0:34 offset1:98
    v_lshrrev_b32 v4, 2, v4
    v_lshlrev_b32 v5, 2, v28
    v_and_b32 v5, 0x1c, v5
    v_and_or_b32 v4, v4, s71, v5
    v_lshlrev_b32 v3, v108, v249
    ds_or_b32 v4, v3 offset:4608
    s_mov_b64 exec, s[58:59]
    v_min_u32 v109, 0x1ff, v109
    v_lshrrev_b32 v3, 15, v29
    v_lshlrev_b32 v4, 9, v13
    v_and_b32 v3, 0x1ffe0, v3
    v_lshl_add_u32 v4, v109, 2, v4
    v_add3_u32 v3, v3, v7, s67
    v_lshlrev_b32 v5, 4, v29
    v_and_b32 v5, 0x1ffff0, v5
    ds_write2st64_b32 v4, v5, v3 offset0:34 offset1:98
    v_lshrrev_b32 v4, 2, v4
    v_lshlrev_b32 v5, 2, v29
    v_and_b32 v5, 0x1c, v5
    v_and_or_b32 v4, v4, s71, v5
    v_lshlrev_b32 v3, v109, v249
    ds_or_b32 v4, v3 offset:4608
    s_mov_b64 exec, -1
    s_waitcnt lgkmcnt(0)
    s_branch KF_RB2
KF_HB3:
    s_waitcnt lgkmcnt(8)
    s_mov_b32 s67, 15728640
    s_mov_b64 exec, s[60:61]
    v_lshrrev_b32 v3, 15, v30
    v_and_b32 v14, 0x1c, v3
    ds_add_rtn_u32 v110, v14, v249 offset:4352
    s_mov_b64 exec, s[62:63]
    v_lshrrev_b32 v3, 15, v31
    v_and_b32 v15, 0x1c, v3
    ds_add_rtn_u32 v111, v15, v249 offset:4352
    s_waitcnt lgkmcnt(0)
    s_mov_b64 exec, s[60:61]
    v_min_u32 v110, 0x1ff, v110
    v_lshrrev_b32 v3, 15, v30
    v_lshlrev_b32 v4, 9, v14
    v_and_b32 v3, 0x1ffe0, v3
    v_lshl_add_u32 v4, v110, 2, v4
    v_add3_u32 v3, v3, v7, s67
    v_lshlrev_b32 v5, 4, v30
    v_and_b32 v5, 0x1ffff0, v5
    ds_write2st64_b32 v4, v5, v3 offset0:34 offset1:98
    v_lshrrev_b32 v4, 2, v4
    v_lshlrev_b32 v5, 2, v30
    v_and_b32 v5, 0x1c, v5
    v_and_or_b32 v4, v4, s71, v5
    v_lshlrev_b32 v3, v110, v249
    ds_or_b32 v4, v3 offset:4608
    s_mov_b64 exec, s[62:63]
    v_min_u32 v111, 0x1ff, v111
    v_lshrrev_b32 v3, 15, v31
    v_lshlrev_b32 v4, 9, v15
    v_and_b32 v3, 0x1ffe0, v3
    v_lshl_add_u32 v4, v111, 2, v4
    v_add3_u32 v3, v3, v7, s67
    v_lshlrev_b32 v5, 4, v31
    v_and_b32 v5, 0x1ffff0, v5
    ds_write2st64_b32 v4, v5, v3 offset0:34 offset1:98
    v_lshrrev_b32 v4, 2, v4
    v_lshlrev_b32 v5, 2, v31
    v_and_b32 v5, 0x1c, v5
    v_and_or_b32 v4, v4, s71, v5
    v_lshlrev_b32 v3, v111, v249
    ds_or_b32 v4, v3 offset:4608
    s_mov_b64 exec, -1
    s_waitcnt lgkmcnt(0)
    s_branch KF_RB3
KFM_HB0:
    s_waitcnt lgkmcnt(8)
    s_mov_b32 s67, 0
    s_mov_b64 exec, s[48:49]
    v_lshrrev_b32 v3, 15, v24
    v_and_b32 v8, 0x1c, v3
    ds_add_rtn_u32 v104, v8, v249 offset:4352
    s_mov_b64 exec, s[50:51]
    v_lshrrev_b32 v3, 15, v25
    v_and_b32 v9, 0x1c, v3
    ds_add_rtn_u32 v105, v9, v249 offset:4352
    s_waitcnt lgkmcnt(0)
    s_mov_b64 exec, s[48:49]
    v_min_u32 v104, 0x1ff, v104
    v_lshrrev_b32 v3, 15, v24
    v_lshlrev_b32 v4, 9, v8
    v_and_b32 v3, 0x1ffe0, v3
    v_lshl_add_u32 v4, v104, 2, v4
    v_add3_u32 v3, v3, v7, s67
    v_lshlrev_b32 v5, 4, v24
    v_and_b32 v5, 0x1ffff0, v5
    ds_write2st64_b32 v4, v5, v3 offset0:34 offset1:98
    v_lshrrev_b32 v4, 2, v4
    v_lshlrev_b32 v5, 2, v24
    v_and_b32 v5, 0x1c, v5
    v_and_or_b32 v4, v4, s71, v5
    v_lshlrev_b32 v3, v104, v249
    ds_or_b32 v4, v3 offset:4608
    s_mov_b64 exec, s[50:51]
    v_min_u32 v105, 0x1ff, v105
    v_lshrrev_b32 v3, 15, v25
    v_lshlrev_b32 v4, 9, v9
    v_and_b32 v3, 0x1ffe0, v3
    v_lshl_add_u32 v4, v105, 2, v4
    v_add3_u32 v3, v3, v7, s67
    v_lshlrev_b32 v5, 4, v25
    v_and_b32 v5, 0x1ffff0, v5
    ds_write2st64_b32 v4, v5, v3 offset0:34 offset1:98
    v_lshrrev_b32 v4, 2, v4
    v_lshlrev_b32 v5, 2, v25
    v_and_b32 v5, 0x1c, v5
    v_and_or_b32 v4, v4, s71, v5
    v_lshlrev_b32 v3, v105, v249
    ds_or_b32 v4, v3 offset:4608
    s_mov_b64 exec, -1
    s_waitcnt lgkmcnt(0)
    s_branch KFM_RB0
KFM_HB1:
    s_waitcnt lgkmcnt(8)
    s_mov_b32 s67, 5242880
    s_mov_b64 exec, s[52:53]
    v_lshrrev_b32 v3, 15, v26
    v_and_b32 v10, 0x1c, v3
    ds_add_rtn_u32 v106, v10, v249 offset:4352
    s_mov_b64 exec, s[54:55]
    v_lshrrev_b32 v3, 15, v27
    v_and_b32 v11, 0x1c, v3
    ds_add_rtn_u32 v107, v11, v249 offset:4352
    s_waitcnt lgkmcnt(0)
    s_mov_b64 exec, s[52:53]
    v_min_u32 v106, 0x1ff, v106
    v_lshrrev_b32 v3, 15, v26
    v_lshlrev_b32 v4, 9, v10
    v_and_b32 v3, 0x1ffe0, v3
    v_lshl_add_u32 v4, v106, 2, v4
    v_add3_u32 v3, v3, v7, s67
    v_lshlrev_b32 v5, 4, v26
    v_and_b32 v5, 0x1ffff0, v5
    ds_write2st64_b32 v4, v5, v3 offset0:34 offset1:98
    v_lshrrev_b32 v4, 2, v4
    v_lshlrev_b32 v5, 2, v26
    v_and_b32 v5, 0x1c, v5
    v_and_or_b32 v4, v4, s71, v5
    v_lshlrev_b32 v3, v106, v249
    ds_or_b32 v4, v3 offset:4608
    s_mov_b64 exec, s[54:55]
    v_min_u32 v107, 0x1ff, v107
    v_lshrrev_b32 v3, 15, v27
    v_lshlrev_b32 v4, 9, v11
    v_and_b32 v3, 0x1ffe0, v3
    v_lshl_add_u32 v4, v107, 2, v4
    v_add3_u32 v3, v3, v7, s67
    v_lshlrev_b32 v5, 4, v27
    v_and_b32 v5, 0x1ffff0, v5
    ds_write2st64_b32 v4, v5, v3 offset0:34 offset1:98
    v_lshrrev_b32 v4, 2, v4
    v_lshlrev_b32 v5, 2, v27
    v_and_b32 v5, 0x1c, v5
    v_and_or_b32 v4, v4, s71, v5
    v_lshlrev_b32 v3, v107, v249
    ds_or_b32 v4, v3 offset:4608
    s_mov_b64 exec, -1
    s_waitcnt lgkmcnt(0)
    s_branch KFM_RB1
KFM_HB2:
    s_waitcnt lgkmcnt(8)
    s_mov_b32 s67, 10485760
    s_mov_b64 exec, s[56:57]
    v_lshrrev_b32 v3, 15, v28
    v_and_b32 v12, 0x1c, v3
    ds_add_rtn_u32 v108, v12, v249 offset:4352
    s_mov_b64 exec, s[58:59]
    v_lshrrev_b32 v3, 15, v29
    v_and_b32 v13, 0x1c, v3
    ds_add_rtn_u32 v109, v13, v249 offset:4352
    s_waitcnt lgkmcnt(0)
    s_mov_b64 exec, s[56:57]
    v_min_u32 v108, 0x1ff, v108
    v_lshrrev_b32 v3, 15, v28
    v_lshlrev_b32 v4, 9, v12
    v_and_b32 v3, 0x1ffe0, v3
    v_lshl_add_u32 v4, v108, 2, v4
    v_add3_u32 v3, v3, v7, s67
    v_lshlrev_b32 v5, 4, v28
    v_and_b32 v5, 0x1ffff0, v5
    ds_write2st64_b32 v4, v5, v3 offset0:34 offset1:98
    v_lshrrev_b32 v4, 2, v4
    v_lshlrev_b32 v5, 2, v28
    v_and_b32 v5, 0x1c, v5
    v_and_or_b32 v4, v4, s71, v5
    v_lshlrev_b32 v3, v108, v249
    ds_or_b32 v4, v3 offset:4608
    s_mov_b64 exec, s[58:59]
    v_min_u32 v109, 0x1ff, v109
    v_lshrrev_b32 v3, 15, v29
    v_lshlrev_b32 v4, 9, v13
    v_and_b32 v3, 0x1ffe0, v3
    v_lshl_add_u32 v4, v109, 2, v4
    v_add3_u32 v3, v3, v7, s67
    v_lshlrev_b32 v5, 4, v29
    v_and_b32 v5, 0x1ffff0, v5
    ds_write2st64_b32 v4, v5, v3 offset0:34 offset1:98
    v_lshrrev_b32 v4, 2, v4
    v_lshlrev_b32 v5, 2, v29
    v_and_b32 v5, 0x1c, v5
    v_and_or_b32 v4, v4, s71, v5
    v_lshlrev_b32 v3, v109, v249
    ds_or_b32 v4, v3 offset:4608
    s_mov_b64 exec, -1
    s_waitcnt lgkmcnt(0)
    s_branch KFM_RB2
KFM_HB3:
    s_waitcnt lgkmcnt(8)
    s_mov_b32 s67, 15728640
    s_mov_b64 exec, s[60:61]
    v_lshrrev_b32 v3, 15, v30
    v_and_b32 v14, 0x1c, v3
    ds_add_rtn_u32 v110, v14, v249 offset:4352
    s_mov_b64 exec, s[62:63]
    v_lshrrev_b32 v3, 15, v31
    v_and_b32 v15, 0x1c, v3
    ds_add_rtn_u32 v111, v15, v249 offset:4352
    s_waitcnt lgkmcnt(0)
    s_mov_b64 exec, s[60:61]
    v_min_u32 v110, 0x1ff, v110
    v_lshrrev_b32 v3, 15, v30
    v_lshlrev_b32 v4, 9, v14
    v_and_b32 v3, 0x1ffe0, v3
    v_lshl_add_u32 v4, v110, 2, v4
    v_add3_u32 v3, v3, v7, s67
    v_lshlrev_b32 v5, 4, v30
    v_and_b32 v5, 0x1ffff0, v5
    ds_write2st64_b32 v4, v5, v3 offset0:34 offset1:98
    v_lshrrev_b32 v4, 2, v4
    v_lshlrev_b32 v5, 2, v30
    v_and_b32 v5, 0x1c, v5
    v_and_or_b32 v4, v4, s71, v5
    v_lshlrev_b32 v3, v110, v249
    ds_or_b32 v4, v3 offset:4608
    s_mov_b64 exec, s[62:63]
    v_min_u32 v111, 0x1ff, v111
    v_lshrrev_b32 v3, 15, v31
    v_lshlrev_b32 v4, 9, v15
    v_and_b32 v3, 0x1ffe0, v3
    v_lshl_add_u32 v4, v111, 2, v4
    v_add3_u32 v3, v3, v7, s67
    v_lshlrev_b32 v5, 4, v31
    v_and_b32 v5, 0x1ffff0, v5
    ds_write2st64_b32 v4, v5, v3 offset0:34 offset1:98
    v_lshrrev_b32 v4, 2, v4
    v_lshlrev_b32 v5, 2, v31
    v_and_b32 v5, 0x1c, v5
    v_and_or_b32 v4, v4, s71, v5
    v_lshlrev_b32 v3, v111, v249
    ds_or_b32 v4, v3 offset:4608
    s_mov_b64 exec, -1
    s_waitcnt lgkmcnt(0)
    s_branch KFM_RB3
KF_MORE:
    s_waitcnt lgkmcnt(0)
    v_and_b32 v3, 0xffff, v96
    v_lshrrev_b32 v4, 16, v96
    v_add_u32 v3, 32, v3
    v_min_u32 v3, v3, v4
    v_lshl_or_b32 v96, v4, 16, v3
    v_and_b32 v3, 0xffff, v97
    v_lshrrev_b32 v4, 16, v97
    v_add_u32 v3, 32, v3
    v_min_u32 v3, v3, v4
    v_lshl_or_b32 v97, v4, 16, v3
    v_and_b32 v3, 0xffff, v98
    v_lshrrev_b32 v4, 16, v98
    v_add_u32 v3, 32, v3
    v_min_u32 v3, v3, v4
    v_lshl_or_b32 v98, v4, 16, v3
    v_and_b32 v3, 0xffff, v99
    v_lshrrev_b32 v4, 16, v99
    v_add_u32 v3, 32, v3
    v_min_u32 v3, v3, v4
    v_lshl_or_b32 v99, v4, 16, v3
    v_mov_b32 v6, 0
    v_and_b32 v3, 0xffff, v96
    v_lshrrev_b32 v4, 16, v96
    v_add_u32 v3, v3, v2
    s_mov_b32 s67, 0
    v_sub_u32 v4, v4, v3
    v_lshl_add_u32 v104, v3, 2, v0
    v_cmp_lt_i32 s[48:49], 16, v4
    buffer_load_dwordx2 v[16:17], v104, s[12:15], s67 offen sc1
    v_cmp_lt_i32 s[32:33], 0, v4
    v_cmp_lt_i32 s[34:35], 1, v4
    v_max_i32 v6, v6, v4
    s_cmp_eq_u64 s[48:49], 0
    s_cbranch_scc1 KFM_NB0
    v_cmp_lt_i32 s[50:51], 17, v4
    s_mov_b64 exec, s[48:49]
    buffer_load_dwordx2 v[24:25], v104, s[12:15], s67 offen offset:64 sc1
    s_mov_b64 exec, -1
KFM_NB0:
    v_and_b32 v3, 0xffff, v97
    v_lshrrev_b32 v4, 16, v97
    v_add_u32 v3, v3, v2
    s_mov_b32 s67, 655360
    v_sub_u32 v4, v4, v3
    v_lshl_add_u32 v105, v3, 2, v0
    v_cmp_lt_i32 s[52:53], 16, v4
    buffer_load_dwordx2 v[18:19], v105, s[12:15], s67 offen sc1
    v_cmp_lt_i32 s[36:37], 0, v4
    v_cmp_lt_i32 s[38:39], 1, v4
    v_max_i32 v6, v6, v4
    s_cmp_eq_u64 s[52:53], 0
    s_cbranch_scc1 KFM_NB1
    v_cmp_lt_i32 s[54:55], 17, v4
    s_mov_b64 exec, s[52:53]
    buffer_load_dwordx2 v[26:27], v105, s[12:15], s67 offen offset:64 sc1
    s_mov_b64 exec, -1
KFM_NB1:
    v_and_b32 v3, 0xffff, v98
    v_lshrrev_b32 v4, 16, v98
    v_add_u32 v3, v3, v2
    s_mov_b32 s67, 1310720
    v_sub_u32 v4, v4, v3
    v_lshl_add_u32 v106, v3, 2, v0
    v_cmp_lt_i32 s[56:57], 16, v4
    buffer_load_dwordx2 v[20:21], v106, s[12:15], s67 offen sc1
    v_cmp_lt_i32 s[40:41], 0, v4
    v_cmp_lt_i32 s[42:43], 1, v4
    v_max_i32 v6, v6, v4
    s_cmp_eq_u64 s[56:57], 0
    s_cbranch_scc1 KFM_NB2
    v_cmp_lt_i32 s[58:59], 17, v4
    s_mov_b64 exec, s[56:57]
    buffer_load_dwordx2 v[28:29], v106, s[12:15], s67 offen offset:64 sc1
    s_mov_b64 exec, -1
KFM_NB2:
    v_and_b32 v3, 0xffff, v99
    v_lshrrev_b32 v4, 16, v99
    v_add_u32 v3, v3, v2
    s_mov_b32 s67, 1966080
    v_sub_u32 v4, v4, v3
    v_lshl_add_u32 v107, v3, 2, v0
    v_cmp_lt_i32 s[60:61], 16, v4
    buffer_load_dwordx2 v[22:23], v107, s[12:15], s67 offen sc1
    v_cmp_lt_i32 s[44:45], 0, v4
    v_cmp_lt_i32 s[46:47], 1, v4
    v_max_i32 v6, v6, v4
    s_cmp_eq_u64 s[60:61], 0
    s_cbranch_scc1 KFM_NB3
    v_cmp_lt_i32 s[62:63], 17, v4
    s_mov_b64 exec, s[60:61]
    buffer_load_dwordx2 v[30:31], v107, s[12:15], s67 offen offset:64 sc1
    s_mov_b64 exec, -1
KFM_NB3:
    v_cmp_lt_i32 vcc, 32, v6
    s_nop 0
    s_or_b32 s73, vcc_lo, vcc_hi
    s_waitcnt vmcnt(0)
    s_mov_b64 exec, s[32:33]
    v_lshrrev_b32 v3, 15, v16
    v_and_b32 v8, 0x1c, v3
    ds_add_rtn_u32 v104, v8, v249 offset:4352
    s_mov_b64 exec, s[34:35]
    v_lshrrev_b32 v3, 15, v17
    v_and_b32 v9, 0x1c, v3
    ds_add_rtn_u32 v105, v9, v249 offset:4352
    s_mov_b64 exec, s[36:37]
    v_lshrrev_b32 v3, 15, v18
    v_and_b32 v10, 0x1c, v3
    ds_add_rtn_u32 v106, v10, v249 offset:4352
    s_mov_b64 exec, s[38:39]
    v_lshrrev_b32 v3, 15, v19
    v_and_b32 v11, 0x1c, v3
    ds_add_rtn_u32 v107, v11, v249 offset:4352
    s_mov_b64 exec, s[40:41]
    v_lshrrev_b32 v3, 15, v20
    v_and_b32 v12, 0x1c, v3
    ds_add_rtn_u32 v108, v12, v249 offset:4352
    s_mov_b64 exec, s[42:43]
    v_lshrrev_b32 v3, 15, v21
    v_and_b32 v13, 0x1c, v3
    ds_add_rtn_u32 v109, v13, v249 offset:4352
    s_mov_b64 exec, s[44:45]
    v_lshrrev_b32 v3, 15, v22
    v_and_b32 v14, 0x1c, v3
    ds_add_rtn_u32 v110, v14, v249 offset:4352
    s_mov_b64 exec, s[46:47]
    v_lshrrev_b32 v3, 15, v23
    v_and_b32 v15, 0x1c, v3
    ds_add_rtn_u32 v111, v15, v249 offset:4352
    s_waitcnt lgkmcnt(7)
    s_mov_b64 exec, s[32:33]
    s_mov_b32 s67, 0
    v_min_u32 v104, 0x1ff, v104
    v_lshrrev_b32 v3, 15, v16
    v_lshlrev_b32 v4, 9, v8
    v_and_b32 v3, 0x1ffe0, v3
    v_lshl_add_u32 v4, v104, 2, v4
    v_add3_u32 v3, v3, v7, s67
    v_lshlrev_b32 v5, 4, v16
    v_and_b32 v5, 0x1ffff0, v5
    ds_write2st64_b32 v4, v5, v3 offset0:34 offset1:98
    v_lshrrev_b32 v4, 2, v4
    v_lshlrev_b32 v5, 2, v16
    v_and_b32 v5, 0x1c, v5
    v_and_or_b32 v4, v4, s71, v5
    v_lshlrev_b32 v3, v104, v249
    ds_or_b32 v4, v3 offset:4608
    s_waitcnt lgkmcnt(8)
    s_mov_b64 exec, s[34:35]
    s_mov_b32 s67, 0
    v_min_u32 v105, 0x1ff, v105
    v_lshrrev_b32 v3, 15, v17
    v_lshlrev_b32 v4, 9, v9
    v_and_b32 v3, 0x1ffe0, v3
    v_lshl_add_u32 v4, v105, 2, v4
    v_add3_u32 v3, v3, v7, s67
    v_lshlrev_b32 v5, 4, v17
    v_and_b32 v5, 0x1ffff0, v5
    ds_write2st64_b32 v4, v5, v3 offset0:34 offset1:98
    v_lshrrev_b32 v4, 2, v4
    v_lshlrev_b32 v5, 2, v17
    v_and_b32 v5, 0x1c, v5
    v_and_or_b32 v4, v4, s71, v5
    v_lshlrev_b32 v3, v105, v249
    ds_or_b32 v4, v3 offset:4608
    s_waitcnt lgkmcnt(9)
    s_mov_b64 exec, s[36:37]
    s_mov_b32 s67, 5242880
    v_min_u32 v106, 0x1ff, v106
    v_lshrrev_b32 v3, 15, v18
    v_lshlrev_b32 v4, 9, v10
    v_and_b32 v3, 0x1ffe0, v3
    v_lshl_add_u32 v4, v106, 2, v4
    v_add3_u32 v3, v3, v7, s67
    v_lshlrev_b32 v5, 4, v18
    v_and_b32 v5, 0x1ffff0, v5
    ds_write2st64_b32 v4, v5, v3 offset0:34 offset1:98
    v_lshrrev_b32 v4, 2, v4
    v_lshlrev_b32 v5, 2, v18
    v_and_b32 v5, 0x1c, v5
    v_and_or_b32 v4, v4, s71, v5
    v_lshlrev_b32 v3, v106, v249
    ds_or_b32 v4, v3 offset:4608
    s_waitcnt lgkmcnt(10)
    s_mov_b64 exec, s[38:39]
    s_mov_b32 s67, 5242880
    v_min_u32 v107, 0x1ff, v107
    v_lshrrev_b32 v3, 15, v19
    v_lshlrev_b32 v4, 9, v11
    v_and_b32 v3, 0x1ffe0, v3
    v_lshl_add_u32 v4, v107, 2, v4
    v_add3_u32 v3, v3, v7, s67
    v_lshlrev_b32 v5, 4, v19
    v_and_b32 v5, 0x1ffff0, v5
    ds_write2st64_b32 v4, v5, v3 offset0:34 offset1:98
    v_lshrrev_b32 v4, 2, v4
    v_lshlrev_b32 v5, 2, v19
    v_and_b32 v5, 0x1c, v5
    v_and_or_b32 v4, v4, s71, v5
    v_lshlrev_b32 v3, v107, v249
    ds_or_b32 v4, v3 offset:4608
    s_waitcnt lgkmcnt(9)
    s_mov_b64 exec, s[40:41]
    s_mov_b32 s67, 10485760
    v_min_u32 v108, 0x1ff, v108
    v_lshrrev_b32 v3, 15, v20
    v_lshlrev_b32 v4, 9, v12
    v_and_b32 v3, 0x1ffe0, v3
    v_lshl_add_u32 v4, v108, 2, v4
    v_add3_u32 v3, v3, v7, s67
    v_lshlrev_b32 v5, 4, v20
    v_and_b32 v5, 0x1ffff0, v5
    ds_write2st64_b32 v4, v5, v3 offset0:34 offset1:98
    v_lshrrev_b32 v4, 2, v4
    v_lshlrev_b32 v5, 2, v20
    v_and_b32 v5, 0x1c, v5
    v_and_or_b32 v4, v4, s71, v5
    v_lshlrev_b32 v3, v108, v249
    ds_or_b32 v4, v3 offset:4608
    s_waitcnt lgkmcnt(8)
    s_mov_b64 exec, s[42:43]
    s_mov_b32 s67, 10485760
    v_min_u32 v109, 0x1ff, v109
    v_lshrrev_b32 v3, 15, v21
    v_lshlrev_b32 v4, 9, v13
    v_and_b32 v3, 0x1ffe0, v3
    v_lshl_add_u32 v4, v109, 2, v4
    v_add3_u32 v3, v3, v7, s67
    v_lshlrev_b32 v5, 4, v21
    v_and_b32 v5, 0x1ffff0, v5
    ds_write2st64_b32 v4, v5, v3 offset0:34 offset1:98
    v_lshrrev_b32 v4, 2, v4
    v_lshlrev_b32 v5, 2, v21
    v_and_b32 v5, 0x1c, v5
    v_and_or_b32 v4, v4, s71, v5
    v_lshlrev_b32 v3, v109, v249
    ds_or_b32 v4, v3 offset:4608
    s_waitcnt lgkmcnt(7)
    s_mov_b64 exec, s[44:45]
    s_mov_b32 s67, 15728640
    v_min_u32 v110, 0x1ff, v110
    v_lshrrev_b32 v3, 15, v22
    v_lshlrev_b32 v4, 9, v14
    v_and_b32 v3, 0x1ffe0, v3
    v_lshl_add_u32 v4, v110, 2, v4
    v_add3_u32 v3, v3, v7, s67
    v_lshlrev_b32 v5, 4, v22
    v_and_b32 v5, 0x1ffff0, v5
    ds_write2st64_b32 v4, v5, v3 offset0:34 offset1:98
    v_lshrrev_b32 v4, 2, v4
    v_lshlrev_b32 v5, 2, v22
    v_and_b32 v5, 0x1c, v5
    v_and_or_b32 v4, v4, s71, v5
    v_lshlrev_b32 v3, v110, v249
    ds_or_b32 v4, v3 offset:4608
    s_waitcnt lgkmcnt(6)
    s_mov_b64 exec, s[46:47]
    s_mov_b32 s67, 15728640
    v_min_u32 v111, 0x1ff, v111
    v_lshrrev_b32 v3, 15, v23
    v_lshlrev_b32 v4, 9, v15
    v_and_b32 v3, 0x1ffe0, v3
    v_lshl_add_u32 v4, v111, 2, v4
    v_add3_u32 v3, v3, v7, s67
    v_lshlrev_b32 v5, 4, v23
    v_and_b32 v5, 0x1ffff0, v5
    ds_write2st64_b32 v4, v5, v3 offset0:34 offset1:98
    v_lshrrev_b32 v4, 2, v4
    v_lshlrev_b32 v5, 2, v23
    v_and_b32 v5, 0x1c, v5
    v_and_or_b32 v4, v4, s71, v5
    v_lshlrev_b32 v3, v111, v249
    ds_or_b32 v4, v3 offset:4608
    s_mov_b64 exec, -1
    s_cmp_lg_u64 s[48:49], 0
    s_cbranch_scc1 KFM_HB0
KFM_RB0:
    s_cmp_lg_u64 s[52:53], 0
    s_cbranch_scc1 KFM_HB1
KFM_RB1:
    s_cmp_lg_u64 s[56:57], 0
    s_cbranch_scc1 KFM_HB2
KFM_RB2:
    s_cmp_lg_u64 s[60:61], 0
    s_cbranch_scc1 KFM_HB3
KFM_RB3:
    s_cmp_lg_u32 s73, 0
    s_cbranch_scc1 KF_MORE
    s_branch KF_DONE
K_LATE:
    s_waitcnt lgkmcnt(7)
    v_and_or_b32 v8, v0, s70, v228
    v_and_or_b32 v9, v1, s70, v229
    v_and_or_b32 v10, v2, s70, v230
    v_and_or_b32 v11, v3, s70, v231
    v_or_b32 v12, v4, v233
    s_add_u32 m0, s28, 0
    s_nop 0
    buffer_load_dwordx4 v8, s[4:7], 0 offen lds
    s_add_u32 m0, s28, 1024
    s_nop 0
    buffer_load_dwordx4 v9, s[4:7], 0 offen lds
    s_add_u32 m0, s28, 2048
    s_nop 0
    buffer_load_dwordx4 v10, s[4:7], 0 offen lds
    s_add_u32 m0, s28, 3072
    s_nop 0
    buffer_load_dwordx4 v11, s[4:7], 0 offen lds
    s_add_u32 m0, s28, 4096
    s_nop 0
    buffer_load_dwordx4 v12, s[8:11], 0 offen lds
    s_branch K_LATERET
KS_HB0:
    s_waitcnt lgkmcnt(8)
    s_mov_b32 s67, 0
    s_mov_b64 exec, s[48:49]
    v_lshrrev_b32 v3, 15, v24
    v_and_b32 v8, 0x1c, v3
    ds_add_rtn_u32 v104, v8, v249 offset:4352
    s_mov_b64 exec, s[50:51]
    v_lshrrev_b32 v3, 15, v25
    v_and_b32 v9, 0x1c, v3
    ds_add_rtn_u32 v105, v9, v249 offset:4352
    s_waitcnt lgkmcnt(0)
    s_mov_b64 exec, s[48:49]
    v_min_u32 v104, 0x1ff, v104
    v_lshrrev_b32 v3, 15, v24
    v_lshlrev_b32 v4, 9, v8
    v_and_b32 v3, 0x1ffe0, v3
    v_lshl_add_u32 v4, v104, 2, v4
    v_add3_u32 v3, v3, v7, s67
    v_lshlrev_b32 v5, 4, v24
    v_and_b32 v5, 0x1ffff0, v5
    ds_write2st64_b32 v4, v5, v3 offset0:34 offset1:98
    v_lshrrev_b32 v4, 2, v4
    v_lshlrev_b32 v5, 2, v24
    v_and_b32 v5, 0x1c, v5
    v_and_or_b32 v4, v4, s71, v5
    v_lshlrev_b32 v3, v104, v249
    ds_or_b32 v4, v3 offset:4608
    s_mov_b64 exec, s[50:51]
    v_min_u32 v105, 0x1ff, v105
    v_lshrrev_b32 v3, 15, v25
    v_lshlrev_b32 v4, 9, v9
    v_and_b32 v3, 0x1ffe0, v3
    v_lshl_add_u32 v4, v105, 2, v4
    v_add3_u32 v3, v3, v7, s67
    v_lshlrev_b32 v5, 4, v25
    v_and_b32 v5, 0x1ffff0, v5
    ds_write2st64_b32 v4, v5, v3 offset0:34 offset1:98
    v_lshrrev_b32 v4, 2, v4
    v_lshlrev_b32 v5, 2, v25
    v_and_b32 v5, 0x1c, v5
    v_and_or_b32 v4, v4, s71, v5
    v_lshlrev_b32 v3, v105, v249
    ds_or_b32 v4, v3 offset:4608
    s_mov_b64 exec, -1
    s_waitcnt lgkmcnt(0)
    s_branch KS_RB0
KS_HB1:
    s_waitcnt lgkmcnt(8)
    s_mov_b32 s67, 5242880
    s_mov_b64 exec, s[52:53]
    v_lshrrev_b32 v3, 15, v26
    v_and_b32 v10, 0x1c, v3
    ds_add_rtn_u32 v106, v10, v249 offset:4352
    s_mov_b64 exec, s[54:55]
    v_lshrrev_b32 v3, 15, v27
    v_and_b32 v11, 0x1c, v3
    ds_add_rtn_u32 v107, v11, v249 offset:4352
    s_waitcnt lgkmcnt(0)
    s_mov_b64 exec, s[52:53]
    v_min_u32 v106, 0x1ff, v106
    v_lshrrev_b32 v3, 15, v26
    v_lshlrev_b32 v4, 9, v10
    v_and_b32 v3, 0x1ffe0, v3
    v_lshl_add_u32 v4, v106, 2, v4
    v_add3_u32 v3, v3, v7, s67
    v_lshlrev_b32 v5, 4, v26
    v_and_b32 v5, 0x1ffff0, v5
    ds_write2st64_b32 v4, v5, v3 offset0:34 offset1:98
    v_lshrrev_b32 v4, 2, v4
    v_lshlrev_b32 v5, 2, v26
    v_and_b32 v5, 0x1c, v5
    v_and_or_b32 v4, v4, s71, v5
    v_lshlrev_b32 v3, v106, v249
    ds_or_b32 v4, v3 offset:4608
    s_mov_b64 exec, s[54:55]
    v_min_u32 v107, 0x1ff, v107
    v_lshrrev_b32 v3, 15, v27
    v_lshlrev_b32 v4, 9, v11
    v_and_b32 v3, 0x1ffe0, v3
    v_lshl_add_u32 v4, v107, 2, v4
    v_add3_u32 v3, v3, v7, s67
    v_lshlrev_b32 v5, 4, v27
    v_and_b32 v5, 0x1ffff0, v5
    ds_write2st64_b32 v4, v5, v3 offset0:34 offset1:98
    v_lshrrev_b32 v4, 2, v4
    v_lshlrev_b32 v5, 2, v27
    v_and_b32 v5, 0x1c, v5
    v_and_or_b32 v4, v4, s71, v5
    v_lshlrev_b32 v3, v107, v249
    ds_or_b32 v4, v3 offset:4608
    s_mov_b64 exec, -1
    s_waitcnt lgkmcnt(0)
    s_branch KS_RB1
KS_HB2:
    s_waitcnt lgkmcnt(8)
    s_mov_b32 s67, 10485760
    s_mov_b64 exec, s[56:57]
    v_lshrrev_b32 v3, 15, v28
    v_and_b32 v12, 0x1c, v3
    ds_add_rtn_u32 v108, v12, v249 offset:4352
    s_mov_b64 exec, s[58:59]
    v_lshrrev_b32 v3, 15, v29
    v_and_b32 v13, 0x1c, v3
    ds_add_rtn_u32 v109, v13, v249 offset:4352
    s_waitcnt lgkmcnt(0)
    s_mov_b64 exec, s[56:57]
    v_min_u32 v108, 0x1ff, v108
    v_lshrrev_b32 v3, 15, v28
    v_lshlrev_b32 v4, 9, v12
    v_and_b32 v3, 0x1ffe0, v3
    v_lshl_add_u32 v4, v108, 2, v4
    v_add3_u32 v3, v3, v7, s67
    v_lshlrev_b32 v5, 4, v28
    v_and_b32 v5, 0x1ffff0, v5
    ds_write2st64_b32 v4, v5, v3 offset0:34 offset1:98
    v_lshrrev_b32 v4, 2, v4
    v_lshlrev_b32 v5, 2, v28
    v_and_b32 v5, 0x1c, v5
    v_and_or_b32 v4, v4, s71, v5
    v_lshlrev_b32 v3, v108, v249
    ds_or_b32 v4, v3 offset:4608
    s_mov_b64 exec, s[58:59]
    v_min_u32 v109, 0x1ff, v109
    v_lshrrev_b32 v3, 15, v29
    v_lshlrev_b32 v4, 9, v13
    v_and_b32 v3, 0x1ffe0, v3
    v_lshl_add_u32 v4, v109, 2, v4
    v_add3_u32 v3, v3, v7, s67
    v_lshlrev_b32 v5, 4, v29
    v_and_b32 v5, 0x1ffff0, v5
    ds_write2st64_b32 v4, v5, v3 offset0:34 offset1:98
    v_lshrrev_b32 v4, 2, v4
    v_lshlrev_b32 v5, 2, v29
    v_and_b32 v5, 0x1c, v5
    v_and_or_b32 v4, v4, s71, v5
    v_lshlrev_b32 v3, v109, v249
    ds_or_b32 v4, v3 offset:4608
    s_mov_b64 exec, -1
    s_waitcnt lgkmcnt(0)
    s_branch KS_RB2
KS_HB3:
    s_waitcnt lgkmcnt(8)
    s_mov_b32 s67, 15728640
    s_mov_b64 exec, s[60:61]
    v_lshrrev_b32 v3, 15, v30
    v_and_b32 v14, 0x1c, v3
    ds_add_rtn_u32 v110, v14, v249 offset:4352
    s_mov_b64 exec, s[62:63]
    v_lshrrev_b32 v3, 15, v31
    v_and_b32 v15, 0x1c, v3
    ds_add_rtn_u32 v111, v15, v249 offset:4352
    s_waitcnt lgkmcnt(0)
    s_mov_b64 exec, s[60:61]
    v_min_u32 v110, 0x1ff, v110
    v_lshrrev_b32 v3, 15, v30
    v_lshlrev_b32 v4, 9, v14
    v_and_b32 v3, 0x1ffe0, v3
    v_lshl_add_u32 v4, v110, 2, v4
    v_add3_u32 v3, v3, v7, s67
    v_lshlrev_b32 v5, 4, v30
    v_and_b32 v5, 0x1ffff0, v5
    ds_write2st64_b32 v4, v5, v3 offset0:34 offset1:98
    v_lshrrev_b32 v4, 2, v4
    v_lshlrev_b32 v5, 2, v30
    v_and_b32 v5, 0x1c, v5
    v_and_or_b32 v4, v4, s71, v5
    v_lshlrev_b32 v3, v110, v249
    ds_or_b32 v4, v3 offset:4608
    s_mov_b64 exec, s[62:63]
    v_min_u32 v111, 0x1ff, v111
    v_lshrrev_b32 v3, 15, v31
    v_lshlrev_b32 v4, 9, v15
    v_and_b32 v3, 0x1ffe0, v3
    v_lshl_add_u32 v4, v111, 2, v4
    v_add3_u32 v3, v3, v7, s67
    v_lshlrev_b32 v5, 4, v31
    v_and_b32 v5, 0x1ffff0, v5
    ds_write2st64_b32 v4, v5, v3 offset0:34 offset1:98
    v_lshrrev_b32 v4, 2, v4
    v_lshlrev_b32 v5, 2, v31
    v_and_b32 v5, 0x1c, v5
    v_and_or_b32 v4, v4, s71, v5
    v_lshlrev_b32 v3, v111, v249
    ds_or_b32 v4, v3 offset:4608
    s_mov_b64 exec, -1
    s_waitcnt lgkmcnt(0)
    s_branch KS_RB3
KSM_HB0:
    s_waitcnt lgkmcnt(8)
    s_mov_b32 s67, 0
    s_mov_b64 exec, s[48:49]
    v_lshrrev_b32 v3, 15, v24
    v_and_b32 v8, 0x1c, v3
    ds_add_rtn_u32 v104, v8, v249 offset:4352
    s_mov_b64 exec, s[50:51]
    v_lshrrev_b32 v3, 15, v25
    v_and_b32 v9, 0x1c, v3
    ds_add_rtn_u32 v105, v9, v249 offset:4352
    s_waitcnt lgkmcnt(0)
    s_mov_b64 exec, s[48:49]
    v_min_u32 v104, 0x1ff, v104
    v_lshrrev_b32 v3, 15, v24
    v_lshlrev_b32 v4, 9, v8
    v_and_b32 v3, 0x1ffe0, v3
    v_lshl_add_u32 v4, v104, 2, v4
    v_add3_u32 v3, v3, v7, s67
    v_lshlrev_b32 v5, 4, v24
    v_and_b32 v5, 0x1ffff0, v5
    ds_write2st64_b32 v4, v5, v3 offset0:34 offset1:98
    v_lshrrev_b32 v4, 2, v4
    v_lshlrev_b32 v5, 2, v24
    v_and_b32 v5, 0x1c, v5
    v_and_or_b32 v4, v4, s71, v5
    v_lshlrev_b32 v3, v104, v249
    ds_or_b32 v4, v3 offset:4608
    s_mov_b64 exec, s[50:51]
    v_min_u32 v105, 0x1ff, v105
    v_lshrrev_b32 v3, 15, v25
    v_lshlrev_b32 v4, 9, v9
    v_and_b32 v3, 0x1ffe0, v3
    v_lshl_add_u32 v4, v105, 2, v4
    v_add3_u32 v3, v3, v7, s67
    v_lshlrev_b32 v5, 4, v25
    v_and_b32 v5, 0x1ffff0, v5
    ds_write2st64_b32 v4, v5, v3 offset0:34 offset1:98
    v_lshrrev_b32 v4, 2, v4
    v_lshlrev_b32 v5, 2, v25
    v_and_b32 v5, 0x1c, v5
    v_and_or_b32 v4, v4, s71, v5
    v_lshlrev_b32 v3, v105, v249
    ds_or_b32 v4, v3 offset:4608
    s_mov_b64 exec, -1
    s_waitcnt lgkmcnt(0)
    s_branch KSM_RB0
KSM_HB1:
    s_waitcnt lgkmcnt(8)
    s_mov_b32 s67, 5242880
    s_mov_b64 exec, s[52:53]
    v_lshrrev_b32 v3, 15, v26
    v_and_b32 v10, 0x1c, v3
    ds_add_rtn_u32 v106, v10, v249 offset:4352
    s_mov_b64 exec, s[54:55]
    v_lshrrev_b32 v3, 15, v27
    v_and_b32 v11, 0x1c, v3
    ds_add_rtn_u32 v107, v11, v249 offset:4352
    s_waitcnt lgkmcnt(0)
    s_mov_b64 exec, s[52:53]
    v_min_u32 v106, 0x1ff, v106
    v_lshrrev_b32 v3, 15, v26
    v_lshlrev_b32 v4, 9, v10
    v_and_b32 v3, 0x1ffe0, v3
    v_lshl_add_u32 v4, v106, 2, v4
    v_add3_u32 v3, v3, v7, s67
    v_lshlrev_b32 v5, 4, v26
    v_and_b32 v5, 0x1ffff0, v5
    ds_write2st64_b32 v4, v5, v3 offset0:34 offset1:98
    v_lshrrev_b32 v4, 2, v4
    v_lshlrev_b32 v5, 2, v26
    v_and_b32 v5, 0x1c, v5
    v_and_or_b32 v4, v4, s71, v5
    v_lshlrev_b32 v3, v106, v249
    ds_or_b32 v4, v3 offset:4608
    s_mov_b64 exec, s[54:55]
    v_min_u32 v107, 0x1ff, v107
    v_lshrrev_b32 v3, 15, v27
    v_lshlrev_b32 v4, 9, v11
    v_and_b32 v3, 0x1ffe0, v3
    v_lshl_add_u32 v4, v107, 2, v4
    v_add3_u32 v3, v3, v7, s67
    v_lshlrev_b32 v5, 4, v27
    v_and_b32 v5, 0x1ffff0, v5
    ds_write2st64_b32 v4, v5, v3 offset0:34 offset1:98
    v_lshrrev_b32 v4, 2, v4
    v_lshlrev_b32 v5, 2, v27
    v_and_b32 v5, 0x1c, v5
    v_and_or_b32 v4, v4, s71, v5
    v_lshlrev_b32 v3, v107, v249
    ds_or_b32 v4, v3 offset:4608
    s_mov_b64 exec, -1
    s_waitcnt lgkmcnt(0)
    s_branch KSM_RB1
KSM_HB2:
    s_waitcnt lgkmcnt(8)
    s_mov_b32 s67, 10485760
    s_mov_b64 exec, s[56:57]
    v_lshrrev_b32 v3, 15, v28
    v_and_b32 v12, 0x1c, v3
    ds_add_rtn_u32 v108, v12, v249 offset:4352
    s_mov_b64 exec, s[58:59]
    v_lshrrev_b32 v3, 15, v29
    v_and_b32 v13, 0x1c, v3
    ds_add_rtn_u32 v109, v13, v249 offset:4352
    s_waitcnt lgkmcnt(0)
    s_mov_b64 exec, s[56:57]
    v_min_u32 v108, 0x1ff, v108
    v_lshrrev_b32 v3, 15, v28
    v_lshlrev_b32 v4, 9, v12
    v_and_b32 v3, 0x1ffe0, v3
    v_lshl_add_u32 v4, v108, 2, v4
    v_add3_u32 v3, v3, v7, s67
    v_lshlrev_b32 v5, 4, v28
    v_and_b32 v5, 0x1ffff0, v5
    ds_write2st64_b32 v4, v5, v3 offset0:34 offset1:98
    v_lshrrev_b32 v4, 2, v4
    v_lshlrev_b32 v5, 2, v28
    v_and_b32 v5, 0x1c, v5
    v_and_or_b32 v4, v4, s71, v5
    v_lshlrev_b32 v3, v108, v249
    ds_or_b32 v4, v3 offset:4608
    s_mov_b64 exec, s[58:59]
    v_min_u32 v109, 0x1ff, v109
    v_lshrrev_b32 v3, 15, v29
    v_lshlrev_b32 v4, 9, v13
    v_and_b32 v3, 0x1ffe0, v3
    v_lshl_add_u32 v4, v109, 2, v4
    v_add3_u32 v3, v3, v7, s67
    v_lshlrev_b32 v5, 4, v29
    v_and_b32 v5, 0x1ffff0, v5
    ds_write2st64_b32 v4, v5, v3 offset0:34 offset1:98
    v_lshrrev_b32 v4, 2, v4
    v_lshlrev_b32 v5, 2, v29
    v_and_b32 v5, 0x1c, v5
    v_and_or_b32 v4, v4, s71, v5
    v_lshlrev_b32 v3, v109, v249
    ds_or_b32 v4, v3 offset:4608
    s_mov_b64 exec, -1
    s_waitcnt lgkmcnt(0)
    s_branch KSM_RB2
KSM_HB3:
    s_waitcnt lgkmcnt(8)
    s_mov_b32 s67, 15728640
    s_mov_b64 exec, s[60:61]
    v_lshrrev_b32 v3, 15, v30
    v_and_b32 v14, 0x1c, v3
    ds_add_rtn_u32 v110, v14, v249 offset:4352
    s_mov_b64 exec, s[62:63]
    v_lshrrev_b32 v3, 15, v31
    v_and_b32 v15, 0x1c, v3
    ds_add_rtn_u32 v111, v15, v249 offset:4352
    s_waitcnt lgkmcnt(0)
    s_mov_b64 exec, s[60:61]
    v_min_u32 v110, 0x1ff, v110
    v_lshrrev_b32 v3, 15, v30
    v_lshlrev_b32 v4, 9, v14
    v_and_b32 v3, 0x1ffe0, v3
    v_lshl_add_u32 v4, v110, 2, v4
    v_add3_u32 v3, v3, v7, s67
    v_lshlrev_b32 v5, 4, v30
    v_and_b32 v5, 0x1ffff0, v5
    ds_write2st64_b32 v4, v5, v3 offset0:34 offset1:98
    v_lshrrev_b32 v4, 2, v4
    v_lshlrev_b32 v5, 2, v30
    v_and_b32 v5, 0x1c, v5
    v_and_or_b32 v4, v4, s71, v5
    v_lshlrev_b32 v3, v110, v249
    ds_or_b32 v4, v3 offset:4608
    s_mov_b64 exec, s[62:63]
    v_min_u32 v111, 0x1ff, v111
    v_lshrrev_b32 v3, 15, v31
    v_lshlrev_b32 v4, 9, v15
    v_and_b32 v3, 0x1ffe0, v3
    v_lshl_add_u32 v4, v111, 2, v4
    v_add3_u32 v3, v3, v7, s67
    v_lshlrev_b32 v5, 4, v31
    v_and_b32 v5, 0x1ffff0, v5
    ds_write2st64_b32 v4, v5, v3 offset0:34 offset1:98
    v_lshrrev_b32 v4, 2, v4
    v_lshlrev_b32 v5, 2, v31
    v_and_b32 v5, 0x1c, v5
    v_and_or_b32 v4, v4, s71, v5
    v_lshlrev_b32 v3, v111, v249
    ds_or_b32 v4, v3 offset:4608
    s_mov_b64 exec, -1
    s_waitcnt lgkmcnt(0)
    s_branch KSM_RB3
KS_MORE:
    s_waitcnt lgkmcnt(0)
    v_and_b32 v3, 0xffff, v96
    v_lshrrev_b32 v4, 16, v96
    v_add_u32 v3, 32, v3
    v_min_u32 v3, v3, v4
    v_lshl_or_b32 v96, v4, 16, v3
    v_and_b32 v3, 0xffff, v97
    v_lshrrev_b32 v4, 16, v97
    v_add_u32 v3, 32, v3
    v_min_u32 v3, v3, v4
    v_lshl_or_b32 v97, v4, 16, v3
    v_and_b32 v3, 0xffff, v98
    v_lshrrev_b32 v4, 16, v98
    v_add_u32 v3, 32, v3
    v_min_u32 v3, v3, v4
    v_lshl_or_b32 v98, v4, 16, v3
    v_and_b32 v3, 0xffff, v99
    v_lshrrev_b32 v4, 16, v99
    v_add_u32 v3, 32, v3
    v_min_u32 v3, v3, v4
    v_lshl_or_b32 v99, v4, 16, v3
    v_mov_b32 v6, 0
    v_and_b32 v3, 0xffff, v96
    v_lshrrev_b32 v4, 16, v96
    v_add_u32 v3, v3, v2
    s_mov_b32 s67, 0
    v_sub_u32 v4, v4, v3
    v_lshl_add_u32 v104, v3, 2, v0
    v_cmp_lt_i32 s[48:49], 16, v4
    buffer_load_dwordx2 v[16:17], v104, s[12:15], s67 offen sc1
    v_cmp_lt_i32 s[32:33], 0, v4
    v_cmp_lt_i32 s[34:35], 1, v4
    v_max_i32 v6, v6, v4
    s_cmp_eq_u64 s[48:49], 0
    s_cbranch_scc1 KSM_NB0
    v_cmp_lt_i32 s[50:51], 17, v4
    s_mov_b64 exec, s[48:49]
    buffer_load_dwordx2 v[24:25], v104, s[12:15], s67 offen offset:64 sc1
    s_mov_b64 exec, -1
KSM_NB0:
    v_and_b32 v3, 0xffff, v97
    v_lshrrev_b32 v4, 16, v97
    v_add_u32 v3, v3, v2
    s_mov_b32 s67, 655360
    v_sub_u32 v4, v4, v3
    v_lshl_add_u32 v105, v3, 2, v0
    v_cmp_lt_i32 s[52:53], 16, v4
    buffer_load_dwordx2 v[18:19], v105, s[12:15], s67 offen sc1
    v_cmp_lt_i32 s[36:37], 0, v4
    v_cmp_lt_i32 s[38:39], 1, v4
    v_max_i32 v6, v6, v4
    s_cmp_eq_u64 s[52:53], 0
    s_cbranch_scc1 KSM_NB1
    v_cmp_lt_i32 s[54:55], 17, v4
    s_mov_b64 exec, s[52:53]
    buffer_load_dwordx2 v[26:27], v105, s[12:15], s67 offen offset:64 sc1
    s_mov_b64 exec, -1
KSM_NB1:
    v_and_b32 v3, 0xffff, v98
    v_lshrrev_b32 v4, 16, v98
    v_add_u32 v3, v3, v2
    s_mov_b32 s67, 1310720
    v_sub_u32 v4, v4, v3
    v_lshl_add_u32 v106, v3, 2, v0
    v_cmp_lt_i32 s[56:57], 16, v4
    buffer_load_dwordx2 v[20:21], v106, s[12:15], s67 offen sc1
    v_cmp_lt_i32 s[40:41], 0, v4
    v_cmp_lt_i32 s[42:43], 1, v4
    v_max_i32 v6, v6, v4
    s_cmp_eq_u64 s[56:57], 0
    s_cbranch_scc1 KSM_NB2
    v_cmp_lt_i32 s[58:59], 17, v4
    s_mov_b64 exec, s[56:57]
    buffer_load_dwordx2 v[28:29], v106, s[12:15], s67 offen offset:64 sc1
    s_mov_b64 exec, -1
KSM_NB2:
    v_and_b32 v3, 0xffff, v99
    v_lshrrev_b32 v4, 16, v99
    v_add_u32 v3, v3, v2
    s_mov_b32 s67, 1966080
    v_sub_u32 v4, v4, v3
    v_lshl_add_u32 v107, v3, 2, v0
    v_cmp_lt_i32 s[60:61], 16, v4
    buffer_load_dwordx2 v[22:23], v107, s[12:15], s67 offen sc1
    v_cmp_lt_i32 s[44:45], 0, v4
    v_cmp_lt_i32 s[46:47], 1, v4
    v_max_i32 v6, v6, v4
    s_cmp_eq_u64 s[60:61], 0
    s_cbranch_scc1 KSM_NB3
    v_cmp_lt_i32 s[62:63], 17, v4
    s_mov_b64 exec, s[60:61]
    buffer_load_dwordx2 v[30:31], v107, s[12:15], s67 offen offset:64 sc1
    s_mov_b64 exec, -1
KSM_NB3:
    v_cmp_lt_i32 vcc, 32, v6
    s_nop 0
    s_or_b32 s73, vcc_lo, vcc_hi
    s_waitcnt vmcnt(0)
    s_mov_b64 exec, s[32:33]
    v_lshrrev_b32 v3, 15, v16
    v_and_b32 v8, 0x1c, v3
    ds_add_rtn_u32 v104, v8, v249 offset:4352
    s_mov_b64 exec, s[34:35]
    v_lshrrev_b32 v3, 15, v17
    v_and_b32 v9, 0x1c, v3
    ds_add_rtn_u32 v105, v9, v249 offset:4352
    s_mov_b64 exec, s[36:37]
    v_lshrrev_b32 v3, 15, v18
    v_and_b32 v10, 0x1c, v3
    ds_add_rtn_u32 v106, v10, v249 offset:4352
    s_mov_b64 exec, s[38:39]
    v_lshrrev_b32 v3, 15, v19
    v_and_b32 v11, 0x1c, v3
    ds_add_rtn_u32 v107, v11, v249 offset:4352
    s_mov_b64 exec, s[40:41]
    v_lshrrev_b32 v3, 15, v20
    v_and_b32 v12, 0x1c, v3
    ds_add_rtn_u32 v108, v12, v249 offset:4352
    s_mov_b64 exec, s[42:43]
    v_lshrrev_b32 v3, 15, v21
    v_and_b32 v13, 0x1c, v3
    ds_add_rtn_u32 v109, v13, v249 offset:4352
    s_mov_b64 exec, s[44:45]
    v_lshrrev_b32 v3, 15, v22
    v_and_b32 v14, 0x1c, v3
    ds_add_rtn_u32 v110, v14, v249 offset:4352
    s_mov_b64 exec, s[46:47]
    v_lshrrev_b32 v3, 15, v23
    v_and_b32 v15, 0x1c, v3
    ds_add_rtn_u32 v111, v15, v249 offset:4352
    s_waitcnt lgkmcnt(7)
    s_mov_b64 exec, s[32:33]
    s_mov_b32 s67, 0
    v_min_u32 v104, 0x1ff, v104
    v_lshrrev_b32 v3, 15, v16
    v_lshlrev_b32 v4, 9, v8
    v_and_b32 v3, 0x1ffe0, v3
    v_lshl_add_u32 v4, v104, 2, v4
    v_add3_u32 v3, v3, v7, s67
    v_lshlrev_b32 v5, 4, v16
    v_and_b32 v5, 0x1ffff0, v5
    ds_write2st64_b32 v4, v5, v3 offset0:34 offset1:98
    v_lshrrev_b32 v4, 2, v4
    v_lshlrev_b32 v5, 2, v16
    v_and_b32 v5, 0x1c, v5
    v_and_or_b32 v4, v4, s71, v5
    v_lshlrev_b32 v3, v104, v249
    ds_or_b32 v4, v3 offset:4608
    s_waitcnt lgkmcnt(8)
    s_mov_b64 exec, s[34:35]
    s_mov_b32 s67, 0
    v_min_u32 v105, 0x1ff, v105
    v_lshrrev_b32 v3, 15, v17
    v_lshlrev_b32 v4, 9, v9
    v_and_b32 v3, 0x1ffe0, v3
    v_lshl_add_u32 v4, v105, 2, v4
    v_add3_u32 v3, v3, v7, s67
    v_lshlrev_b32 v5, 4, v17
    v_and_b32 v5, 0x1ffff0, v5
    ds_write2st64_b32 v4, v5, v3 offset0:34 offset1:98
    v_lshrrev_b32 v4, 2, v4
    v_lshlrev_b32 v5, 2, v17
    v_and_b32 v5, 0x1c, v5
    v_and_or_b32 v4, v4, s71, v5
    v_lshlrev_b32 v3, v105, v249
    ds_or_b32 v4, v3 offset:4608
    s_waitcnt lgkmcnt(9)
    s_mov_b64 exec, s[36:37]
    s_mov_b32 s67, 5242880
    v_min_u32 v106, 0x1ff, v106
    v_lshrrev_b32 v3, 15, v18
    v_lshlrev_b32 v4, 9, v10
    v_and_b32 v3, 0x1ffe0, v3
    v_lshl_add_u32 v4, v106, 2, v4
    v_add3_u32 v3, v3, v7, s67
    v_lshlrev_b32 v5, 4, v18
    v_and_b32 v5, 0x1ffff0, v5
    ds_write2st64_b32 v4, v5, v3 offset0:34 offset1:98
    v_lshrrev_b32 v4, 2, v4
    v_lshlrev_b32 v5, 2, v18
    v_and_b32 v5, 0x1c, v5
    v_and_or_b32 v4, v4, s71, v5
    v_lshlrev_b32 v3, v106, v249
    ds_or_b32 v4, v3 offset:4608
    s_waitcnt lgkmcnt(10)
    s_mov_b64 exec, s[38:39]
    s_mov_b32 s67, 5242880
    v_min_u32 v107, 0x1ff, v107
    v_lshrrev_b32 v3, 15, v19
    v_lshlrev_b32 v4, 9, v11
    v_and_b32 v3, 0x1ffe0, v3
    v_lshl_add_u32 v4, v107, 2, v4
    v_add3_u32 v3, v3, v7, s67
    v_lshlrev_b32 v5, 4, v19
    v_and_b32 v5, 0x1ffff0, v5
    ds_write2st64_b32 v4, v5, v3 offset0:34 offset1:98
    v_lshrrev_b32 v4, 2, v4
    v_lshlrev_b32 v5, 2, v19
    v_and_b32 v5, 0x1c, v5
    v_and_or_b32 v4, v4, s71, v5
    v_lshlrev_b32 v3, v107, v249
    ds_or_b32 v4, v3 offset:4608
    s_waitcnt lgkmcnt(9)
    s_mov_b64 exec, s[40:41]
    s_mov_b32 s67, 10485760
    v_min_u32 v108, 0x1ff, v108
    v_lshrrev_b32 v3, 15, v20
    v_lshlrev_b32 v4, 9, v12
    v_and_b32 v3, 0x1ffe0, v3
    v_lshl_add_u32 v4, v108, 2, v4
    v_add3_u32 v3, v3, v7, s67
    v_lshlrev_b32 v5, 4, v20
    v_and_b32 v5, 0x1ffff0, v5
    ds_write2st64_b32 v4, v5, v3 offset0:34 offset1:98
    v_lshrrev_b32 v4, 2, v4
    v_lshlrev_b32 v5, 2, v20
    v_and_b32 v5, 0x1c, v5
    v_and_or_b32 v4, v4, s71, v5
    v_lshlrev_b32 v3, v108, v249
    ds_or_b32 v4, v3 offset:4608
    s_waitcnt lgkmcnt(8)
    s_mov_b64 exec, s[42:43]
    s_mov_b32 s67, 10485760
    v_min_u32 v109, 0x1ff, v109
    v_lshrrev_b32 v3, 15, v21
    v_lshlrev_b32 v4, 9, v13
    v_and_b32 v3, 0x1ffe0, v3
    v_lshl_add_u32 v4, v109, 2, v4
    v_add3_u32 v3, v3, v7, s67
    v_lshlrev_b32 v5, 4, v21
    v_and_b32 v5, 0x1ffff0, v5
    ds_write2st64_b32 v4, v5, v3 offset0:34 offset1:98
    v_lshrrev_b32 v4, 2, v4
    v_lshlrev_b32 v5, 2, v21
    v_and_b32 v5, 0x1c, v5
    v_and_or_b32 v4, v4, s71, v5
    v_lshlrev_b32 v3, v109, v249
    ds_or_b32 v4, v3 offset:4608
    s_waitcnt lgkmcnt(7)
    s_mov_b64 exec, s[44:45]
    s_mov_b32 s67, 15728640
    v_min_u32 v110, 0x1ff, v110
    v_lshrrev_b32 v3, 15, v22
    v_lshlrev_b32 v4, 9, v14
    v_and_b32 v3, 0x1ffe0, v3
    v_lshl_add_u32 v4, v110, 2, v4
    v_add3_u32 v3, v3, v7, s67
    v_lshlrev_b32 v5, 4, v22
    v_and_b32 v5, 0x1ffff0, v5
    ds_write2st64_b32 v4, v5, v3 offset0:34 offset1:98
    v_lshrrev_b32 v4, 2, v4
    v_lshlrev_b32 v5, 2, v22
    v_and_b32 v5, 0x1c, v5
    v_and_or_b32 v4, v4, s71, v5
    v_lshlrev_b32 v3, v110, v249
    ds_or_b32 v4, v3 offset:4608
    s_waitcnt lgkmcnt(6)
    s_mov_b64 exec, s[46:47]
    s_mov_b32 s67, 15728640
    v_min_u32 v111, 0x1ff, v111
    v_lshrrev_b32 v3, 15, v23
    v_lshlrev_b32 v4, 9, v15
    v_and_b32 v3, 0x1ffe0, v3
    v_lshl_add_u32 v4, v111, 2, v4
    v_add3_u32 v3, v3, v7, s67
    v_lshlrev_b32 v5, 4, v23
    v_and_b32 v5, 0x1ffff0, v5
    ds_write2st64_b32 v4, v5, v3 offset0:34 offset1:98
    v_lshrrev_b32 v4, 2, v4
    v_lshlrev_b32 v5, 2, v23
    v_and_b32 v5, 0x1c, v5
    v_and_or_b32 v4, v4, s71, v5
    v_lshlrev_b32 v3, v111, v249
    ds_or_b32 v4, v3 offset:4608
    s_mov_b64 exec, -1
    s_cmp_lg_u64 s[48:49], 0
    s_cbranch_scc1 KSM_HB0
KSM_RB0:
    s_cmp_lg_u64 s[52:53], 0
    s_cbranch_scc1 KSM_HB1
KSM_RB1:
    s_cmp_lg_u64 s[56:57], 0
    s_cbranch_scc1 KSM_HB2
KSM_RB2:
    s_cmp_lg_u64 s[60:61], 0
    s_cbranch_scc1 KSM_HB3
KSM_RB3:
    s_cmp_lg_u32 s73, 0
    s_cbranch_scc1 KS_MORE
    s_branch KS_DONE
K_END:
    s_endpgm
.section .rodata,"a"
.p2align 6
.amdhsa_kernel gather_scatter__edge_featured_mpnn_gatedgcn__graph_kernel
.amdhsa_next_free_vgpr 256
.amdhsa_next_free_sgpr 102
.amdhsa_accum_offset 256
.amdhsa_group_segment_fixed_size 0
.amdhsa_kernarg_size 96
.amdhsa_user_sgpr_count 2
.amdhsa_user_sgpr_kernarg_segment_ptr 1
.amdhsa_system_sgpr_workgroup_id_x 1
.end_amdhsa_kernel
```
